```python
import torch

def _softmax(x, axis=-1):
    return torch.softmax(x, dim=axis)
def _gelu(x):
    return torch.nn.functional.gelu(x, approximate="tanh")
def _silu(x):
    return torch.nn.functional.silu(x)
def _sigmoid(x):
    return torch.sigmoid(x)
def _layernorm(x, axis=-1, eps=1e-5):
    m = x.mean(dim=axis, keepdim=True)
    v = x.var(dim=axis, keepdim=True, unbiased=False)
    return (x - m) / torch.sqrt(v + eps)
def _scatter_add(tgt, idx, src, axis=0):
    return tgt.clone().index_add_(axis, idx, src)
def _segment_sum(src, seg, n):
    out = torch.zeros((n,) + src.shape[1:], dtype=src.dtype)
    return out.index_add_(0, seg, src)
def _pad(x, pw):
    flat = tuple(v for pair in reversed(pw) for v in pair)
    return torch.nn.functional.pad(x, flat)

kernel_name = 'standalone__dense_activation_relu__prompt'

def setup_inputs():

    _w = (lambda a: (lambda t: t.to(torch.bfloat16) if t.is_floating_point() else t)(torch.as_tensor(a)))
    B, S, D, Dff = 1, 2048, 640, 1728
    return {
        "x": _w((lambda *s: torch.randn(*s, dtype=torch.bfloat16) * 0.05)(B, S, D)),
        "w1": _w((lambda *s: torch.randn(*s, dtype=torch.bfloat16) * 0.05)(D, Dff)),
        "w2": _w((lambda *s: torch.randn(*s, dtype=torch.bfloat16) * 0.05)(Dff, D)),
    }

def reference(x, w1, w2):
    h = torch.einsum("bsd,df->bsf", x, w1)
    zero = torch.zeros_like(h)
    h = torch.maximum(h, zero)
    return torch.einsum("bsf,fd->bsd", h, w2)
```

```asm
; @launch grid=(256,1,1) block=(256,1,1) lds=163840
.amdgcn_target "amdgcn-amd-amdhsa--gfx950"
.text
.globl standalone__dense_activation_relu__prompt_kernel
.p2align 8
.type standalone__dense_activation_relu__prompt_kernel,@function
standalone__dense_activation_relu__prompt_kernel:
    s_load_dwordx8 s[4:11], s[0:1], 0
    s_getpc_b64 s[60:61]
L_pc:
    s_load_dwordx4 s[12:15], s[0:1], 32
    s_cmp_ge_u32 s2, 256
    s_cbranch_scc1 L_end
    v_and_b32 v1, 63, v0
    v_lshrrev_b32 v2, 6, v0
    s_and_b32 s40, s2, 7
    v_readfirstlane_b32 s3, v2
    s_lshr_b32 s41, s2, 3
    s_cmp_ge_u32 s41, 28
    s_cbranch_scc1 L_repack
    s_cmp_ge_u32 s41, 14
    s_cselect_b32 s44, 1, 0
    s_cselect_b32 s45, 14, 0
    s_sub_u32 s43, s41, s45
    s_lshl_b32 s42, s40, 1
    s_add_u32 s42, s42, s44
    s_mul_i32 s96, s43, 3
    s_mul_i32 s46, s44, 5
    s_add_u32 s96, s96, s46
    s_add_u32 s96, s96, s40
    s_mul_i32 s46, s96, 205
    s_lshr_b32 s46, s46, 11
    s_mul_i32 s46, s46, 10
    s_sub_u32 s96, s96, s46
    s_lshl_b32 s48, s3, 12
    s_lshl_b32 s44, s42, 2
    s_add_u32 s44, s44, s3
    s_mul_i32 s97, s44, 40960
    s_mul_i32 s98, s3, 55296
    s_lshl_b32 s44, s43, 8
    s_add_u32 s98, s98, s44
    v_lshrrev_b32 v2, 3, v1
    v_mul_u32_u24 v2, 1280, v2
    v_and_b32 v3, 7, v1
    v_lshrrev_b32 v4, 4, v1
    v_xor_b32 v5, v3, v4
    v_xor_b32 v6, 4, v5
    v_lshl_add_u32 v5, v5, 4, v2
    v_lshl_add_u32 v6, v6, 4, v2
    v_add_u32 v208, 0, v5
    v_add_u32 v209, 9216, v6
    v_add_u32 v210, 18432, v5
    v_add_u32 v211, 27648, v6
    v_mul_u32_u24 v2, 3456, v4
    v_and_b32 v3, 15, v1
    v_lshlrev_b32 v5, 2, v4
    v_xor_b32 v3, v3, v5
    v_lshl_add_u32 v2, v3, 4, v2
    v_add_u32 v212, 0, v2
    v_add_u32 v213, 12800, v2
    v_add_u32 v214, 25600, v2
    v_add_u32 v215, 38400, v2
    s_waitcnt lgkmcnt(0)
    s_mov_b32 s16, s4
    s_mov_b32 s17, s5
    s_mov_b32 s18, 2621440
    s_mov_b32 s19, 0x00020000
    s_mov_b32 s20, s6
    s_mov_b32 s21, s7
    s_mov_b32 s22, 2211840
    s_mov_b32 s23, 0x00020000
    s_add_u32 m0, s48, 0
    s_lshl_b32 s49, s96, 7
    s_add_u32 s49, s49, s97
    buffer_load_dwordx4 v208, s[16:19], s49 offen offset:0 lds
    buffer_load_dwordx4 v209, s[16:19], s49 offen offset:1024 lds
    buffer_load_dwordx4 v210, s[16:19], s49 offen offset:2048 lds
    buffer_load_dwordx4 v211, s[16:19], s49 offen offset:3072 lds
    s_add_u32 m0, s48, 16384
    s_mul_i32 s50, s96, 221184
    s_add_u32 s50, s50, s98
    buffer_load_dwordx4 v212, s[20:23], s50 offen offset:0 lds
    buffer_load_dwordx4 v213, s[20:23], s50 offen offset:1024 lds
    buffer_load_dwordx4 v214, s[20:23], s50 offen offset:2048 lds
    buffer_load_dwordx4 v215, s[20:23], s50 offen offset:3072 lds
    s_add_u32 m0, s48, 32768
    s_add_u32 s96, s96, 1
    s_cmp_eq_u32 s96, 10
    s_cselect_b32 s96, 0, s96
    s_lshl_b32 s49, s96, 7
    s_add_u32 s49, s49, s97
    buffer_load_dwordx4 v208, s[16:19], s49 offen offset:0 lds
    buffer_load_dwordx4 v209, s[16:19], s49 offen offset:1024 lds
    s_mov_b32 s24, s14
    s_mov_b32 s25, s15
    s_mov_b32 s26, 12582912
    s_mov_b32 s27, 0x00020000
    s_mov_b32 s28, s10
    s_mov_b32 s29, s11
    s_mov_b32 s30, 2621440
    s_mov_b32 s31, 0x00020000
    s_mov_b32 s32, s12
    s_mov_b32 s33, s13
    s_mov_b32 s34, 256
    s_mov_b32 s35, 0x00020000
    s_mov_b32 s10, 2211840
    s_mov_b32 s11, 0x00020000
    s_lshl_b32 s62, s41, 2
    s_add_u32 s62, s62, s3
    s_lshl_b32 s62, s62, 6
    s_min_u32 s44, s62, L_codeend-L_pc
    s_load_dword s63, s[60:61], s44
    s_add_u32 s62, s62, 8192
    s_min_u32 s44, s62, L_codeend-L_pc
    s_load_dword s63, s[60:61], s44
    s_add_u32 s62, s62, 8192
    s_min_u32 s44, s62, L_codeend-L_pc
    s_load_dword s63, s[60:61], s44
    s_add_u32 s62, s62, 8192
    v_and_b32 v2, 31, v1
    v_lshrrev_b32 v3, 5, v1
    v_bfe_u32 v4, v1, 1, 3
    s_and_b32 s44, s3, 1
    s_lshr_b32 s45, s3, 1
    s_lshl_b32 s46, s44, 13
    v_lshl_add_u32 v2, v2, 7, s46
    v_or_b32 v5, 0, v3
    v_xor_b32 v5, v5, v4
    v_lshl_add_u32 v216, v5, 4, v2
    v_or_b32 v5, 2, v3
    v_xor_b32 v5, v5, v4
    v_lshl_add_u32 v217, v5, 4, v2
    v_or_b32 v5, 4, v3
    v_xor_b32 v5, v5, v4
    v_lshl_add_u32 v218, v5, 4, v2
    v_or_b32 v5, 6, v3
    v_xor_b32 v5, v5, v4
    v_lshl_add_u32 v219, v5, 4, v2
    v_add_u32 v220, 65536, v216
    v_add_u32 v221, 65536, v217
    v_add_u32 v222, 65536, v218
    v_add_u32 v223, 65536, v219
    v_add_u32 v224, 131072, v216
    v_add_u32 v225, 131072, v217
    v_add_u32 v226, 131072, v218
    v_add_u32 v227, 131072, v219
    v_bfe_u32 v2, v1, 2, 2
    v_lshl_add_u32 v5, v3, 3, v2
    v_lshlrev_b32 v5, 8, v5
    v_and_b32 v6, 1, v1
    v_lshl_add_u32 v5, v6, 3, v5
    v_add_u32 v5, 16384, v5
    v_bfe_u32 v6, v1, 4, 1
    v_bfe_u32 v7, v1, 1, 1
    v_lshl_add_u32 v6, v6, 1, v7
    s_lshl_b32 s46, s45, 3
    v_or_b32 v6, s46, v6
    v_lshlrev_b32 v2, 2, v2
    v_or_b32 v7, 0, v6
    v_xor_b32 v7, v7, v2
    v_lshl_add_u32 v228, v7, 4, v5
    v_or_b32 v7, 4, v6
    v_xor_b32 v7, v7, v2
    v_lshl_add_u32 v229, v7, 4, v5
    v_add_u32 v230, 65536, v228
    v_add_u32 v231, 65536, v229
    v_add_u32 v232, 131072, v228
    v_add_u32 v233, 131072, v229
    v_bfe_u32 v5, v1, 4, 1
    v_and_b32 v6, 15, v1
    v_lshl_add_u32 v6, v3, 4, v6
    v_lshlrev_b32 v6, 4, v6
    v_lshl_add_u32 v8, v5, 10, v6
    s_lshl_b32 s46, s42, 1
    s_add_u32 s46, s46, s44
    s_lshl_b32 s47, s43, 1
    s_add_u32 s47, s47, s45
    s_mov_b32 s0, s46
    s_lshl_b32 s100, s46, 5
    s_add_u32 s100, s100, s47
    s_lshl_b32 s100, s100, 7
    s_add_u32 s100, s100, 10485760
    s_mul_i32 s46, s46, 27
    s_add_u32 s46, s46, s47
    s_lshl_b32 s51, s46, 13
    s_cmp_ge_u32 s47, 27
    s_cselect_b32 s51, 1073741824, s51
    s_cselect_b32 s100, 1073741824, s100
    s_add_u32 s52, s51, 4096
    s_lshl_b32 s53, s40, 2
    s_lshr_b32 s44, s41, 3
    s_add_u32 s53, s53, s44
    s_and_b32 s54, s41, 7
    s_mul_i32 s38, s3, 40960
    s_mul_i32 s44, s54, 160
    s_add_u32 s38, s38, s44
    s_mul_i32 s4, s3, 5120
    s_mul_i32 s5, s3, 40960
    s_mul_i32 s44, s54, 5120
    s_add_u32 s5, s5, s44
    s_add_u32 s5, s5, 7340032
    s_mul_i32 s39, s53, 54
    s_add_u32 s39, s39, s3
    s_lshl_b32 s39, s39, 12
    s_cmp_ge_u32 s3, 2
    s_cselect_b32 s99, 10, 99
    s_and_b32 s44, s53, 3
    s_lshl_b32 s45, s44, 1
    s_add_u32 s36, s45, s54
    s_cmp_ge_u32 s36, 3
    s_cselect_b32 s45, 3, 0
    s_sub_u32 s36, s36, s45
    s_cmp_ge_u32 s36, 3
    s_cselect_b32 s45, 3, 0
    s_sub_u32 s36, s36, s45
    s_cmp_ge_u32 s36, 3
    s_cselect_b32 s45, 3, 0
    s_sub_u32 s36, s36, s45
    s_cmp_ge_u32 s36, 3
    s_cselect_b32 s45, 3, 0
    s_sub_u32 s36, s36, s45
    s_lshl_b32 s44, s44, 1
    s_add_u32 s6, s44, s54
    s_cmp_ge_u32 s6, 11
    s_cselect_b32 s45, 11, 0
    s_sub_u32 s6, s6, s45
    s_mov_b32 s37, s36
    s_mov_b32 s7, s6
    v_lshlrev_b32 v10, 4, v1
    v_add_u32 v11, 4096, v10
    s_add_u32 s44, s3, 0
    s_and_b32 s44, s44, 3
    s_lshl_b32 s45, s44, 10
    v_add_u32 v12, s45, v10
    s_add_u32 s44, s3, 1
    s_and_b32 s44, s44, 3
    s_lshl_b32 s45, s44, 10
    v_add_u32 v13, s45, v10
    s_mul_i32 s45, s44, 15360
    s_add_u32 s45, s45, 0
    v_add_u32 v16, s45, v10
    s_add_u32 s44, s3, 2
    s_and_b32 s44, s44, 3
    s_lshl_b32 s45, s44, 10
    v_add_u32 v14, s45, v10
    s_mul_i32 s45, s44, 15360
    s_add_u32 s45, s45, 5120
    v_add_u32 v17, s45, v10
    s_add_u32 s44, s3, 3
    s_and_b32 s44, s44, 3
    s_lshl_b32 s45, s44, 10
    v_add_u32 v15, s45, v10
    s_mul_i32 s45, s44, 15360
    s_add_u32 s45, s45, 10240
    v_add_u32 v18, s45, v10
    s_mul_i32 s45, s3, 15360
    v_add_u32 v19, s45, v10
    v_and_b32 v2, 15, v1
    v_mul_u32_u24 v2, 1280, v2
    v_lshrrev_b32 v3, 4, v1
    v_lshl_add_u32 v20, v3, 3, v2
    s_lshl_b32 s44, s53, 2
    s_add_u32 s44, s44, s3
    s_mul_i32 s101, s44, 20480
    s_mul_i32 s45, s54, 160
    s_add_u32 s101, s101, s45
    v_min_u32 v2, 13, v1
    s_lshr_b32 s45, s3, 1
    v_lshl_add_u32 v2, v2, 1, s45
    v_min_u32 v2, 26, v2
    s_lshl_b32 s44, s53, 12
    s_add_u32 s44, s44, 10485760
    v_lshl_add_u32 v21, v2, 7, s44
    v_min_u32 v2, 7, v1
    s_lshl_b32 s44, s0, 10
    s_add_u32 s44, s44, 10878976
    v_lshl_add_u32 v134, v2, 7, s44
    s_lshl_b32 s0, s53, 3
    s_add_u32 s0, s0, s54
    s_lshl_b32 s0, s0, 7
    s_add_u32 s0, s0, 10878976
    s_cmp_eq_u32 s3, 0
    s_cselect_b32 s0, s0, 1073741824
    v_min_u32 v2, 21, v1
    v_lshrrev_b32 v3, 1, v2
    v_lshl_add_u32 v3, v3, 2, s3
    v_min_u32 v3, 41, v3
    v_mul_u32_u24 v3, 10, v3
    v_and_b32 v2, 1, v2
    s_mul_i32 s44, s54, 5
    s_lshr_b32 s44, s44, 2
    v_add3_u32 v2, v2, v3, s44
    v_lshlrev_b32 v2, 7, v2
    v_add_u32 v22, 10747904, v2
    v_add_u32 v2, 0, v1
    v_mul_u32_u24 v3, 205, v2
    v_lshrrev_b32 v3, 11, v3
    v_mul_u32_u24 v4, 1120, v3
    v_lshl_add_u32 v4, v2, 4, v4
    v_mov_b32 v120, v4
    v_add_u32 v2, 64, v1
    v_mul_u32_u24 v3, 205, v2
    v_lshrrev_b32 v3, 11, v3
    v_mul_u32_u24 v4, 1120, v3
    v_lshl_add_u32 v4, v2, 4, v4
    v_subrev_u32 v121, 1024, v4
    v_add_u32 v2, 128, v1
    v_mul_u32_u24 v3, 205, v2
    v_lshrrev_b32 v3, 11, v3
    v_mul_u32_u24 v4, 1120, v3
    v_lshl_add_u32 v4, v2, 4, v4
    v_subrev_u32 v122, 2048, v4
    v_add_u32 v2, 192, v1
    v_mul_u32_u24 v3, 205, v2
    v_lshrrev_b32 v3, 11, v3
    v_mul_u32_u24 v4, 1120, v3
    v_lshl_add_u32 v4, v2, 4, v4
    v_subrev_u32 v123, 3072, v4
    v_add_u32 v2, 256, v1
    v_mul_u32_u24 v3, 205, v2
    v_lshrrev_b32 v3, 11, v3
    v_mul_u32_u24 v4, 1120, v3
    v_lshl_add_u32 v4, v2, 4, v4
    v_mov_b32 v124, v4
    v_lshrrev_b32 v2, 5, v1
    v_bfe_u32 v3, v1, 4, 1
    v_bfe_u32 v4, v1, 2, 2
    v_lshlrev_b32 v2, 4, v2
    v_lshl_add_u32 v2, v3, 2, v2
    v_add_u32 v2, v2, v4
    v_mul_u32_u24 v2, 160, v2
    v_and_b32 v3, 3, v1
    v_lshl_add_u32 v2, v3, 3, v2
    v_add_u32 v125, s4, v2
    v_add_u32 v126, 61440, v125
    v_add_u32 v127, 122880, v125
    v_lshlrev_b32 v23, 24, v1
    v_mov_b32 v9, 0
    s_getreg_b32 s12, hwreg(HW_REG_XCC_ID)
    s_and_b32 s12, s12, 15
    buffer_load_dwordx4 v210, s[16:19], s49 offen offset:2048 lds
    buffer_load_dwordx4 v211, s[16:19], s49 offen offset:3072 lds
    s_add_u32 m0, s48, 49152
    s_mul_i32 s50, s96, 221184
    s_add_u32 s50, s50, s98
    buffer_load_dwordx4 v212, s[20:23], s50 offen offset:0 lds
    buffer_load_dwordx4 v213, s[20:23], s50 offen offset:1024 lds
    buffer_load_dwordx4 v214, s[20:23], s50 offen offset:2048 lds
    buffer_load_dwordx4 v215, s[20:23], s50 offen offset:3072 lds
    s_add_u32 m0, s48, 65536
    s_add_u32 s96, s96, 1
    s_cmp_eq_u32 s96, 10
    s_cselect_b32 s96, 0, s96
    s_lshl_b32 s49, s96, 7
    s_add_u32 s49, s49, s97
    buffer_load_dwordx4 v208, s[16:19], s49 offen offset:0 lds
    buffer_load_dwordx4 v209, s[16:19], s49 offen offset:1024 lds
    buffer_load_dwordx4 v210, s[16:19], s49 offen offset:2048 lds
    buffer_load_dwordx4 v211, s[16:19], s49 offen offset:3072 lds
    s_waitcnt vmcnt(12)
    s_barrier
    ds_read_b64_tr_b16 v[24:25], v228 offset:0
    ds_read_b64_tr_b16 v[26:27], v228 offset:1024
    ds_read_b128 v[32:35], v216 offset:0
    ds_read_b64_tr_b16 v[28:29], v229 offset:0
    ds_read_b64_tr_b16 v[30:31], v229 offset:1024
    ds_read_b128 v[36:39], v216 offset:4096
    s_waitcnt lgkmcnt(3)
    v_mfma_f32_32x32x16_bf16 v[56:71], v[24:27], v[32:35], 0
    ds_read_b64_tr_b16 v[40:41], v228 offset:4096
    ds_read_b64_tr_b16 v[42:43], v228 offset:5120
    ds_read_b128 v[48:51], v217 offset:0
    s_waitcnt lgkmcnt(4)
    v_mfma_f32_32x32x16_bf16 v[72:87], v[28:31], v[32:35], 0
    ds_read_b64_tr_b16 v[44:45], v229 offset:4096
    ds_read_b64_tr_b16 v[46:47], v229 offset:5120
    ds_read_b128 v[52:55], v217 offset:4096
    s_waitcnt lgkmcnt(6)
    v_mfma_f32_32x32x16_bf16 v[88:103], v[24:27], v[36:39], 0
    s_add_u32 m0, s48, 81920
    s_mul_i32 s50, s96, 221184
    s_add_u32 s50, s50, s98
    buffer_load_dwordx4 v212, s[20:23], s50 offen offset:0 lds
    v_mfma_f32_32x32x16_bf16 v[104:119], v[28:31], v[36:39], 0
    buffer_load_dwordx4 v213, s[20:23], s50 offen offset:1024 lds
    s_waitcnt lgkmcnt(3)
    v_mfma_f32_32x32x16_bf16 v[56:71], v[40:43], v[48:51], v[56:71]
    ds_read_b64_tr_b16 v[24:25], v228 offset:8192
    ds_read_b64_tr_b16 v[26:27], v228 offset:9216
    ds_read_b128 v[32:35], v218 offset:0
    s_waitcnt lgkmcnt(4)
    v_mfma_f32_32x32x16_bf16 v[72:87], v[44:47], v[48:51], v[72:87]
    ds_read_b64_tr_b16 v[28:29], v229 offset:8192
    ds_read_b64_tr_b16 v[30:31], v229 offset:9216
    ds_read_b128 v[36:39], v218 offset:4096
    s_waitcnt lgkmcnt(6)
    v_mfma_f32_32x32x16_bf16 v[88:103], v[40:43], v[52:55], v[88:103]
    buffer_load_dwordx4 v214, s[20:23], s50 offen offset:2048 lds
    v_mfma_f32_32x32x16_bf16 v[104:119], v[44:47], v[52:55], v[104:119]
    buffer_load_dwordx4 v215, s[20:23], s50 offen offset:3072 lds
    s_waitcnt lgkmcnt(3)
    v_mfma_f32_32x32x16_bf16 v[56:71], v[24:27], v[32:35], v[56:71]
    ds_read_b64_tr_b16 v[40:41], v228 offset:12288
    ds_read_b64_tr_b16 v[42:43], v228 offset:13312
    ds_read_b128 v[48:51], v219 offset:0
    s_waitcnt lgkmcnt(4)
    v_mfma_f32_32x32x16_bf16 v[72:87], v[28:31], v[32:35], v[72:87]
    ds_read_b64_tr_b16 v[44:45], v229 offset:12288
    ds_read_b64_tr_b16 v[46:47], v229 offset:13312
    ds_read_b128 v[52:55], v219 offset:4096
    s_waitcnt lgkmcnt(6)
    v_mfma_f32_32x32x16_bf16 v[88:103], v[24:27], v[36:39], v[88:103]
    s_add_u32 m0, s48, 98304
    s_add_u32 s96, s96, 1
    s_cmp_eq_u32 s96, 10
    s_cselect_b32 s96, 0, s96
    s_lshl_b32 s49, s96, 7
    s_add_u32 s49, s49, s97
    buffer_load_dwordx4 v208, s[16:19], s49 offen offset:0 lds
    buffer_load_dwordx2 v[4:5], v9, s[32:35], 0 offen sc1
    v_mfma_f32_32x32x16_bf16 v[104:119], v[28:31], v[36:39], v[104:119]
    buffer_load_dwordx4 v209, s[16:19], s49 offen offset:1024 lds
    s_waitcnt lgkmcnt(3)
    v_mfma_f32_32x32x16_bf16 v[56:71], v[40:43], v[48:51], v[56:71]
    s_waitcnt vmcnt(11) lgkmcnt(0)
    s_barrier
    ds_read_b64_tr_b16 v[24:25], v228 offset:32768
    ds_read_b64_tr_b16 v[26:27], v228 offset:33792
    ds_read_b128 v[32:35], v216 offset:32768
    v_mfma_f32_32x32x16_bf16 v[72:87], v[44:47], v[48:51], v[72:87]
    ds_read_b64_tr_b16 v[28:29], v229 offset:32768
    ds_read_b64_tr_b16 v[30:31], v229 offset:33792
    ds_read_b128 v[36:39], v216 offset:36864
    v_mfma_f32_32x32x16_bf16 v[88:103], v[40:43], v[52:55], v[88:103]
    buffer_load_dwordx4 v210, s[16:19], s49 offen offset:2048 lds
    v_mfma_f32_32x32x16_bf16 v[104:119], v[44:47], v[52:55], v[104:119]
    buffer_load_dwordx4 v211, s[16:19], s49 offen offset:3072 lds
    s_waitcnt lgkmcnt(3)
    v_mfma_f32_32x32x16_bf16 v[56:71], v[24:27], v[32:35], v[56:71]
    ds_read_b64_tr_b16 v[40:41], v228 offset:36864
    ds_read_b64_tr_b16 v[42:43], v228 offset:37888
    ds_read_b128 v[48:51], v217 offset:32768
    s_waitcnt lgkmcnt(4)
    v_mfma_f32_32x32x16_bf16 v[72:87], v[28:31], v[32:35], v[72:87]
    ds_read_b64_tr_b16 v[44:45], v229 offset:36864
    ds_read_b64_tr_b16 v[46:47], v229 offset:37888
    ds_read_b128 v[52:55], v217 offset:36864
    s_waitcnt lgkmcnt(6)
    v_mfma_f32_32x32x16_bf16 v[88:103], v[24:27], v[36:39], v[88:103]
    s_add_u32 m0, s48, 114688
    s_mul_i32 s50, s96, 221184
    s_add_u32 s50, s50, s98
    buffer_load_dwordx4 v212, s[20:23], s50 offen offset:0 lds
    v_mfma_f32_32x32x16_bf16 v[104:119], v[28:31], v[36:39], v[104:119]
    buffer_load_dwordx4 v213, s[20:23], s50 offen offset:1024 lds
    s_waitcnt lgkmcnt(3)
    v_mfma_f32_32x32x16_bf16 v[56:71], v[40:43], v[48:51], v[56:71]
    ds_read_b64_tr_b16 v[24:25], v228 offset:40960
    ds_read_b64_tr_b16 v[26:27], v228 offset:41984
    ds_read_b128 v[32:35], v218 offset:32768
    s_waitcnt lgkmcnt(4)
    v_mfma_f32_32x32x16_bf16 v[72:87], v[44:47], v[48:51], v[72:87]
    ds_read_b64_tr_b16 v[28:29], v229 offset:40960
    ds_read_b64_tr_b16 v[30:31], v229 offset:41984
    ds_read_b128 v[36:39], v218 offset:36864
    s_waitcnt lgkmcnt(6)
    v_mfma_f32_32x32x16_bf16 v[88:103], v[40:43], v[52:55], v[88:103]
    buffer_load_dwordx4 v214, s[20:23], s50 offen offset:2048 lds
    v_mfma_f32_32x32x16_bf16 v[104:119], v[44:47], v[52:55], v[104:119]
    buffer_load_dwordx4 v215, s[20:23], s50 offen offset:3072 lds
    s_waitcnt lgkmcnt(3)
    v_mfma_f32_32x32x16_bf16 v[56:71], v[24:27], v[32:35], v[56:71]
    ds_read_b64_tr_b16 v[40:41], v228 offset:45056
    ds_read_b64_tr_b16 v[42:43], v228 offset:46080
    ds_read_b128 v[48:51], v219 offset:32768
    s_waitcnt lgkmcnt(4)
    v_mfma_f32_32x32x16_bf16 v[72:87], v[28:31], v[32:35], v[72:87]
    ds_read_b64_tr_b16 v[44:45], v229 offset:45056
    ds_read_b64_tr_b16 v[46:47], v229 offset:46080
    ds_read_b128 v[52:55], v219 offset:36864
    s_waitcnt lgkmcnt(6)
    v_mfma_f32_32x32x16_bf16 v[88:103], v[24:27], v[36:39], v[88:103]
    s_add_u32 m0, s48, 131072
    s_add_u32 s96, s96, 1
    s_cmp_eq_u32 s96, 10
    s_cselect_b32 s96, 0, s96
    s_lshl_b32 s49, s96, 7
    s_add_u32 s49, s49, s97
    buffer_load_dwordx4 v208, s[16:19], s49 offen offset:0 lds
    v_mfma_f32_32x32x16_bf16 v[104:119], v[28:31], v[36:39], v[104:119]
    buffer_load_dwordx4 v209, s[16:19], s49 offen offset:1024 lds
    s_waitcnt lgkmcnt(3)
    v_mfma_f32_32x32x16_bf16 v[56:71], v[40:43], v[48:51], v[56:71]
    s_waitcnt vmcnt(11) lgkmcnt(0)
    s_barrier
    ds_read_b64_tr_b16 v[24:25], v230 offset:0
    ds_read_b64_tr_b16 v[26:27], v230 offset:1024
    ds_read_b128 v[32:35], v220 offset:0
    v_mfma_f32_32x32x16_bf16 v[72:87], v[44:47], v[48:51], v[72:87]
    ds_read_b64_tr_b16 v[28:29], v231 offset:0
    ds_read_b64_tr_b16 v[30:31], v231 offset:1024
    ds_read_b128 v[36:39], v220 offset:4096
    v_mfma_f32_32x32x16_bf16 v[88:103], v[40:43], v[52:55], v[88:103]
    buffer_load_dwordx4 v210, s[16:19], s49 offen offset:2048 lds
    v_mfma_f32_32x32x16_bf16 v[104:119], v[44:47], v[52:55], v[104:119]
    buffer_load_dwordx4 v211, s[16:19], s49 offen offset:3072 lds
    s_waitcnt lgkmcnt(3)
    v_mfma_f32_32x32x16_bf16 v[56:71], v[24:27], v[32:35], v[56:71]
    ds_read_b64_tr_b16 v[40:41], v230 offset:4096
    ds_read_b64_tr_b16 v[42:43], v230 offset:5120
    ds_read_b128 v[48:51], v221 offset:0
    s_waitcnt lgkmcnt(4)
    v_mfma_f32_32x32x16_bf16 v[72:87], v[28:31], v[32:35], v[72:87]
    ds_read_b64_tr_b16 v[44:45], v231 offset:4096
    ds_read_b64_tr_b16 v[46:47], v231 offset:5120
    ds_read_b128 v[52:55], v221 offset:4096
    s_waitcnt lgkmcnt(6)
    v_mfma_f32_32x32x16_bf16 v[88:103], v[24:27], v[36:39], v[88:103]
    s_add_u32 m0, s48, 147456
    s_mul_i32 s50, s96, 221184
    s_add_u32 s50, s50, s98
    buffer_load_dwordx4 v212, s[20:23], s50 offen offset:0 lds
    v_mfma_f32_32x32x16_bf16 v[104:119], v[28:31], v[36:39], v[104:119]
    buffer_load_dwordx4 v213, s[20:23], s50 offen offset:1024 lds
    s_waitcnt lgkmcnt(3)
    v_mfma_f32_32x32x16_bf16 v[56:71], v[40:43], v[48:51], v[56:71]
    ds_read_b64_tr_b16 v[24:25], v230 offset:8192
    ds_read_b64_tr_b16 v[26:27], v230 offset:9216
    ds_read_b128 v[32:35], v222 offset:0
    s_waitcnt lgkmcnt(4)
    v_mfma_f32_32x32x16_bf16 v[72:87], v[44:47], v[48:51], v[72:87]
    ds_read_b64_tr_b16 v[28:29], v231 offset:8192
    ds_read_b64_tr_b16 v[30:31], v231 offset:9216
    ds_read_b128 v[36:39], v222 offset:4096
    s_waitcnt lgkmcnt(6)
    v_mfma_f32_32x32x16_bf16 v[88:103], v[40:43], v[52:55], v[88:103]
    buffer_load_dwordx4 v214, s[20:23], s50 offen offset:2048 lds
    v_mfma_f32_32x32x16_bf16 v[104:119], v[44:47], v[52:55], v[104:119]
    buffer_load_dwordx4 v215, s[20:23], s50 offen offset:3072 lds
    s_waitcnt lgkmcnt(3)
    v_mfma_f32_32x32x16_bf16 v[56:71], v[24:27], v[32:35], v[56:71]
    ds_read_b64_tr_b16 v[40:41], v230 offset:12288
    ds_read_b64_tr_b16 v[42:43], v230 offset:13312
    ds_read_b128 v[48:51], v223 offset:0
    s_waitcnt lgkmcnt(4)
    v_mfma_f32_32x32x16_bf16 v[72:87], v[28:31], v[32:35], v[72:87]
    ds_read_b64_tr_b16 v[44:45], v231 offset:12288
    ds_read_b64_tr_b16 v[46:47], v231 offset:13312
    ds_read_b128 v[52:55], v223 offset:4096
    s_waitcnt lgkmcnt(6)
    v_mfma_f32_32x32x16_bf16 v[88:103], v[24:27], v[36:39], v[88:103]
    s_add_u32 m0, s48, 0
    s_add_u32 s96, s96, 1
    s_cmp_eq_u32 s96, 10
    s_cselect_b32 s96, 0, s96
    s_lshl_b32 s49, s96, 7
    s_add_u32 s49, s49, s97
    buffer_load_dwordx4 v208, s[16:19], s49 offen offset:0 lds
    v_mfma_f32_32x32x16_bf16 v[104:119], v[28:31], v[36:39], v[104:119]
    buffer_load_dwordx4 v209, s[16:19], s49 offen offset:1024 lds
    s_waitcnt lgkmcnt(3)
    v_mfma_f32_32x32x16_bf16 v[56:71], v[40:43], v[48:51], v[56:71]
    s_waitcnt vmcnt(10) lgkmcnt(0)
    s_barrier
    ds_read_b64_tr_b16 v[24:25], v230 offset:32768
    ds_read_b64_tr_b16 v[26:27], v230 offset:33792
    ds_read_b128 v[32:35], v220 offset:32768
    v_mfma_f32_32x32x16_bf16 v[72:87], v[44:47], v[48:51], v[72:87]
    ds_read_b64_tr_b16 v[28:29], v231 offset:32768
    ds_read_b64_tr_b16 v[30:31], v231 offset:33792
    ds_read_b128 v[36:39], v220 offset:36864
    v_mfma_f32_32x32x16_bf16 v[88:103], v[40:43], v[52:55], v[88:103]
    buffer_load_dwordx4 v210, s[16:19], s49 offen offset:2048 lds
    v_mfma_f32_32x32x16_bf16 v[104:119], v[44:47], v[52:55], v[104:119]
    buffer_load_dwordx4 v211, s[16:19], s49 offen offset:3072 lds
    s_waitcnt lgkmcnt(3)
    v_mfma_f32_32x32x16_bf16 v[56:71], v[24:27], v[32:35], v[56:71]
    ds_read_b64_tr_b16 v[40:41], v230 offset:36864
    ds_read_b64_tr_b16 v[42:43], v230 offset:37888
    ds_read_b128 v[48:51], v221 offset:32768
    s_waitcnt lgkmcnt(4)
    v_mfma_f32_32x32x16_bf16 v[72:87], v[28:31], v[32:35], v[72:87]
    ds_read_b64_tr_b16 v[44:45], v231 offset:36864
    ds_read_b64_tr_b16 v[46:47], v231 offset:37888
    ds_read_b128 v[52:55], v221 offset:36864
    s_waitcnt lgkmcnt(6)
    v_mfma_f32_32x32x16_bf16 v[88:103], v[24:27], v[36:39], v[88:103]
    s_add_u32 m0, s48, 16384
    s_mul_i32 s50, s96, 221184
    s_add_u32 s50, s50, s98
    buffer_load_dwordx4 v212, s[20:23], s50 offen offset:0 lds
    s_mov_b32 s57, 0
L_spin_n1:
    v_readfirstlane_b32 s58, v4
    v_readfirstlane_b32 s59, v5
    s_add_u32 s57, s57, 1
    s_cmp_lg_u32 s59, 0
    s_cbranch_scc1 L_ok_n1
    s_cmp_ge_u32 s57, 20000
    s_cbranch_scc1 L_ok_n1
    s_sleep 4
    buffer_load_dwordx2 v[4:5], v9, s[32:35], 0 offen sc1
    s_waitcnt vmcnt(0)
    s_branch L_spin_n1
L_ok_n1:
    s_nop 1
    s_xor_b32 s44, s58, s12
    v_mov_b32 v4, s44
    v_mov_b32 v5, s59
    v_mov_b32 v2, s58
    v_mov_b32 v3, s59
    v_mfma_f32_32x32x16_bf16 v[104:119], v[28:31], v[36:39], v[104:119]
    buffer_load_dwordx4 v213, s[20:23], s50 offen offset:1024 lds
    s_waitcnt lgkmcnt(3)
    v_mfma_f32_32x32x16_bf16 v[56:71], v[40:43], v[48:51], v[56:71]
    ds_read_b64_tr_b16 v[24:25], v230 offset:40960
    ds_read_b64_tr_b16 v[26:27], v230 offset:41984
    ds_read_b128 v[32:35], v222 offset:32768
    s_waitcnt lgkmcnt(4)
    v_mfma_f32_32x32x16_bf16 v[72:87], v[44:47], v[48:51], v[72:87]
    ds_read_b64_tr_b16 v[28:29], v231 offset:40960
    ds_read_b64_tr_b16 v[30:31], v231 offset:41984
    ds_read_b128 v[36:39], v222 offset:36864
    s_waitcnt lgkmcnt(6)
    v_mfma_f32_32x32x16_bf16 v[88:103], v[40:43], v[52:55], v[88:103]
    buffer_load_dwordx4 v214, s[20:23], s50 offen offset:2048 lds
    buffer_store_dwordx2 v[4:5], v23, s[24:27], s0 offen sc1
    v_mfma_f32_32x32x16_bf16 v[104:119], v[44:47], v[52:55], v[104:119]
    buffer_load_dwordx4 v215, s[20:23], s50 offen offset:3072 lds
    s_waitcnt lgkmcnt(3)
    v_mfma_f32_32x32x16_bf16 v[56:71], v[24:27], v[32:35], v[56:71]
    ds_read_b64_tr_b16 v[40:41], v230 offset:45056
    ds_read_b64_tr_b16 v[42:43], v230 offset:46080
    ds_read_b128 v[48:51], v223 offset:32768
    s_waitcnt lgkmcnt(4)
    v_mfma_f32_32x32x16_bf16 v[72:87], v[28:31], v[32:35], v[72:87]
    ds_read_b64_tr_b16 v[44:45], v231 offset:45056
    ds_read_b64_tr_b16 v[46:47], v231 offset:46080
    ds_read_b128 v[52:55], v223 offset:36864
    s_waitcnt lgkmcnt(6)
    v_mfma_f32_32x32x16_bf16 v[88:103], v[24:27], v[36:39], v[88:103]
    s_add_u32 m0, s48, 32768
    s_add_u32 s96, s96, 1
    s_cmp_eq_u32 s96, 10
    s_cselect_b32 s96, 0, s96
    s_lshl_b32 s49, s96, 7
    s_add_u32 s49, s49, s97
    buffer_load_dwordx4 v208, s[16:19], s49 offen offset:0 lds
    v_mfma_f32_32x32x16_bf16 v[104:119], v[28:31], v[36:39], v[104:119]
    buffer_load_dwordx4 v209, s[16:19], s49 offen offset:1024 lds
    s_waitcnt lgkmcnt(3)
    v_mfma_f32_32x32x16_bf16 v[56:71], v[40:43], v[48:51], v[56:71]
    s_waitcnt vmcnt(11) lgkmcnt(0)
    s_barrier
    ds_read_b64_tr_b16 v[24:25], v232 offset:0
    ds_read_b64_tr_b16 v[26:27], v232 offset:1024
    ds_read_b128 v[32:35], v224 offset:0
    v_mfma_f32_32x32x16_bf16 v[72:87], v[44:47], v[48:51], v[72:87]
    ds_read_b64_tr_b16 v[28:29], v233 offset:0
    ds_read_b64_tr_b16 v[30:31], v233 offset:1024
    ds_read_b128 v[36:39], v224 offset:4096
    v_mfma_f32_32x32x16_bf16 v[88:103], v[40:43], v[52:55], v[88:103]
    buffer_load_dwordx4 v210, s[16:19], s49 offen offset:2048 lds
    v_mfma_f32_32x32x16_bf16 v[104:119], v[44:47], v[52:55], v[104:119]
    buffer_load_dwordx4 v211, s[16:19], s49 offen offset:3072 lds
    s_waitcnt lgkmcnt(3)
    v_mfma_f32_32x32x16_bf16 v[56:71], v[24:27], v[32:35], v[56:71]
    ds_read_b64_tr_b16 v[40:41], v232 offset:4096
    ds_read_b64_tr_b16 v[42:43], v232 offset:5120
    ds_read_b128 v[48:51], v225 offset:0
    s_waitcnt lgkmcnt(4)
    v_mfma_f32_32x32x16_bf16 v[72:87], v[28:31], v[32:35], v[72:87]
    ds_read_b64_tr_b16 v[44:45], v233 offset:4096
    ds_read_b64_tr_b16 v[46:47], v233 offset:5120
    ds_read_b128 v[52:55], v225 offset:4096
    s_waitcnt lgkmcnt(6)
    v_mfma_f32_32x32x16_bf16 v[88:103], v[24:27], v[36:39], v[88:103]
    s_add_u32 m0, s48, 49152
    s_mul_i32 s50, s96, 221184
    s_add_u32 s50, s50, s98
    buffer_load_dwordx4 v212, s[20:23], s50 offen offset:0 lds
    v_mfma_f32_32x32x16_bf16 v[104:119], v[28:31], v[36:39], v[104:119]
    buffer_load_dwordx4 v213, s[20:23], s50 offen offset:1024 lds
    s_waitcnt lgkmcnt(3)
    v_mfma_f32_32x32x16_bf16 v[56:71], v[40:43], v[48:51], v[56:71]
    ds_read_b64_tr_b16 v[24:25], v232 offset:8192
    ds_read_b64_tr_b16 v[26:27], v232 offset:9216
    ds_read_b128 v[32:35], v226 offset:0
    s_waitcnt lgkmcnt(4)
    v_mfma_f32_32x32x16_bf16 v[72:87], v[44:47], v[48:51], v[72:87]
    ds_read_b64_tr_b16 v[28:29], v233 offset:8192
    ds_read_b64_tr_b16 v[30:31], v233 offset:9216
    ds_read_b128 v[36:39], v226 offset:4096
    s_waitcnt lgkmcnt(6)
    v_mfma_f32_32x32x16_bf16 v[88:103], v[40:43], v[52:55], v[88:103]
    buffer_load_dwordx4 v214, s[20:23], s50 offen offset:2048 lds
    v_mfma_f32_32x32x16_bf16 v[104:119], v[44:47], v[52:55], v[104:119]
    buffer_load_dwordx4 v215, s[20:23], s50 offen offset:3072 lds
    s_waitcnt lgkmcnt(3)
    v_mfma_f32_32x32x16_bf16 v[56:71], v[24:27], v[32:35], v[56:71]
    ds_read_b64_tr_b16 v[40:41], v232 offset:12288
    ds_read_b64_tr_b16 v[42:43], v232 offset:13312
    ds_read_b128 v[48:51], v227 offset:0
    s_waitcnt lgkmcnt(4)
    v_mfma_f32_32x32x16_bf16 v[72:87], v[28:31], v[32:35], v[72:87]
    ds_read_b64_tr_b16 v[44:45], v233 offset:12288
    ds_read_b64_tr_b16 v[46:47], v233 offset:13312
    ds_read_b128 v[52:55], v227 offset:4096
    s_waitcnt lgkmcnt(6)
    v_mfma_f32_32x32x16_bf16 v[88:103], v[24:27], v[36:39], v[88:103]
    s_add_u32 m0, s48, 65536
    s_add_u32 s96, s96, 1
    s_cmp_eq_u32 s96, 10
    s_cselect_b32 s96, 0, s96
    s_lshl_b32 s49, s96, 7
    s_add_u32 s49, s49, s97
    buffer_load_dwordx4 v208, s[16:19], s49 offen offset:0 lds
    s_lshl_b32 s14, s41, 2
    s_add_u32 s14, s14, s3
    s_mul_i32 s14, s14, 3840
    v_lshrrev_b32 v128, 3, v1
    v_lshlrev_b32 v128, 7, v128
    buffer_load_dword v129, v128, s[8:11], s14 offen
    v_mfma_f32_32x32x16_bf16 v[104:119], v[28:31], v[36:39], v[104:119]
    buffer_load_dwordx4 v209, s[16:19], s49 offen offset:1024 lds
    s_waitcnt lgkmcnt(3)
    v_mfma_f32_32x32x16_bf16 v[56:71], v[40:43], v[48:51], v[56:71]
    s_waitcnt vmcnt(11) lgkmcnt(0)
    s_barrier
    ds_read_b64_tr_b16 v[24:25], v228 offset:0
    ds_read_b64_tr_b16 v[26:27], v228 offset:1024
    ds_read_b128 v[32:35], v216 offset:0
    v_mfma_f32_32x32x16_bf16 v[72:87], v[44:47], v[48:51], v[72:87]
    ds_read_b64_tr_b16 v[28:29], v229 offset:0
    ds_read_b64_tr_b16 v[30:31], v229 offset:1024
    ds_read_b128 v[36:39], v216 offset:4096
    v_mfma_f32_32x32x16_bf16 v[88:103], v[40:43], v[52:55], v[88:103]
    buffer_load_dwordx4 v210, s[16:19], s49 offen offset:2048 lds
    s_add_u32 s14, s14, 1024
    buffer_load_dword v129, v128, s[8:11], s14 offen
    v_mfma_f32_32x32x16_bf16 v[104:119], v[44:47], v[52:55], v[104:119]
    buffer_load_dwordx4 v211, s[16:19], s49 offen offset:3072 lds
    s_waitcnt lgkmcnt(3)
    v_mfma_f32_32x32x16_bf16 v[56:71], v[24:27], v[32:35], v[56:71]
    ds_read_b64_tr_b16 v[40:41], v228 offset:4096
    ds_read_b64_tr_b16 v[42:43], v228 offset:5120
    ds_read_b128 v[48:51], v217 offset:0
    s_waitcnt lgkmcnt(4)
    v_mfma_f32_32x32x16_bf16 v[72:87], v[28:31], v[32:35], v[72:87]
    ds_read_b64_tr_b16 v[44:45], v229 offset:4096
    ds_read_b64_tr_b16 v[46:47], v229 offset:5120
    ds_read_b128 v[52:55], v217 offset:4096
    s_waitcnt lgkmcnt(6)
    v_mfma_f32_32x32x16_bf16 v[88:103], v[24:27], v[36:39], v[88:103]
    s_add_u32 m0, s48, 81920
    s_mul_i32 s50, s96, 221184
    s_add_u32 s50, s50, s98
    buffer_load_dwordx4 v212, s[20:23], s50 offen offset:0 lds
    s_add_u32 s14, s14, 1024
    buffer_load_dword v129, v128, s[8:11], s14 offen
    v_mfma_f32_32x32x16_bf16 v[104:119], v[28:31], v[36:39], v[104:119]
    buffer_load_dwordx4 v213, s[20:23], s50 offen offset:1024 lds
    s_waitcnt lgkmcnt(3)
    v_mfma_f32_32x32x16_bf16 v[56:71], v[40:43], v[48:51], v[56:71]
    ds_read_b64_tr_b16 v[24:25], v228 offset:8192
    ds_read_b64_tr_b16 v[26:27], v228 offset:9216
    ds_read_b128 v[32:35], v218 offset:0
    s_waitcnt lgkmcnt(4)
    v_mfma_f32_32x32x16_bf16 v[72:87], v[44:47], v[48:51], v[72:87]
    ds_read_b64_tr_b16 v[28:29], v229 offset:8192
    ds_read_b64_tr_b16 v[30:31], v229 offset:9216
    ds_read_b128 v[36:39], v218 offset:4096
    s_waitcnt lgkmcnt(6)
    v_mfma_f32_32x32x16_bf16 v[88:103], v[40:43], v[52:55], v[88:103]
    buffer_load_dwordx4 v214, s[20:23], s50 offen offset:2048 lds
    s_add_u32 s14, s14, 1024
    buffer_load_dword v129, v128, s[8:11], s14 offen
    v_mfma_f32_32x32x16_bf16 v[104:119], v[44:47], v[52:55], v[104:119]
    buffer_load_dwordx4 v215, s[20:23], s50 offen offset:3072 lds
    s_waitcnt lgkmcnt(3)
    v_mfma_f32_32x32x16_bf16 v[56:71], v[24:27], v[32:35], v[56:71]
    ds_read_b64_tr_b16 v[40:41], v228 offset:12288
    ds_read_b64_tr_b16 v[42:43], v228 offset:13312
    ds_read_b128 v[48:51], v219 offset:0
    s_waitcnt lgkmcnt(4)
    v_mfma_f32_32x32x16_bf16 v[72:87], v[28:31], v[32:35], v[72:87]
    ds_read_b64_tr_b16 v[44:45], v229 offset:12288
    ds_read_b64_tr_b16 v[46:47], v229 offset:13312
    ds_read_b128 v[52:55], v219 offset:4096
    s_waitcnt lgkmcnt(6)
    v_mfma_f32_32x32x16_bf16 v[88:103], v[24:27], v[36:39], v[88:103]
    s_add_u32 m0, s48, 98304
    s_add_u32 s96, s96, 1
    s_cmp_eq_u32 s96, 10
    s_cselect_b32 s96, 0, s96
    s_lshl_b32 s49, s96, 7
    s_add_u32 s49, s49, s97
    buffer_load_dwordx4 v208, s[16:19], s49 offen offset:0 lds
    v_mfma_f32_32x32x16_bf16 v[104:119], v[28:31], v[36:39], v[104:119]
    buffer_load_dwordx4 v209, s[16:19], s49 offen offset:1024 lds
    s_waitcnt lgkmcnt(3)
    v_mfma_f32_32x32x16_bf16 v[56:71], v[40:43], v[48:51], v[56:71]
    s_waitcnt vmcnt(14) lgkmcnt(0)
    s_barrier
    ds_read_b64_tr_b16 v[24:25], v228 offset:32768
    ds_read_b64_tr_b16 v[26:27], v228 offset:33792
    ds_read_b128 v[32:35], v216 offset:32768
    v_mfma_f32_32x32x16_bf16 v[72:87], v[44:47], v[48:51], v[72:87]
    ds_read_b64_tr_b16 v[28:29], v229 offset:32768
    ds_read_b64_tr_b16 v[30:31], v229 offset:33792
    ds_read_b128 v[36:39], v216 offset:36864
    v_mfma_f32_32x32x16_bf16 v[88:103], v[40:43], v[52:55], v[88:103]
    buffer_load_dwordx4 v210, s[16:19], s49 offen offset:2048 lds
    v_mfma_f32_32x32x16_bf16 v[104:119], v[44:47], v[52:55], v[104:119]
    buffer_load_dwordx4 v211, s[16:19], s49 offen offset:3072 lds
    s_waitcnt lgkmcnt(3)
    v_mfma_f32_32x32x16_bf16 v[56:71], v[24:27], v[32:35], v[56:71]
    ds_read_b64_tr_b16 v[40:41], v228 offset:36864
    ds_read_b64_tr_b16 v[42:43], v228 offset:37888
    ds_read_b128 v[48:51], v217 offset:32768
    s_waitcnt lgkmcnt(4)
    v_mfma_f32_32x32x16_bf16 v[72:87], v[28:31], v[32:35], v[72:87]
    ds_read_b64_tr_b16 v[44:45], v229 offset:36864
    ds_read_b64_tr_b16 v[46:47], v229 offset:37888
    ds_read_b128 v[52:55], v217 offset:36864
    s_waitcnt lgkmcnt(6)
    v_mfma_f32_32x32x16_bf16 v[88:103], v[24:27], v[36:39], v[88:103]
    s_add_u32 m0, s48, 114688
    s_mul_i32 s50, s96, 221184
    s_add_u32 s50, s50, s98
    buffer_load_dwordx4 v212, s[20:23], s50 offen offset:0 lds
    buffer_load_dwordx2 v[132:133], v134, s[24:27], 0 offen sc1
    v_mfma_f32_32x32x16_bf16 v[104:119], v[28:31], v[36:39], v[104:119]
    buffer_load_dwordx4 v213, s[20:23], s50 offen offset:1024 lds
    s_waitcnt lgkmcnt(3)
    v_mfma_f32_32x32x16_bf16 v[56:71], v[40:43], v[48:51], v[56:71]
    ds_read_b64_tr_b16 v[24:25], v228 offset:40960
    ds_read_b64_tr_b16 v[26:27], v228 offset:41984
    ds_read_b128 v[32:35], v218 offset:32768
    s_waitcnt lgkmcnt(4)
    v_mfma_f32_32x32x16_bf16 v[72:87], v[44:47], v[48:51], v[72:87]
    ds_read_b64_tr_b16 v[28:29], v229 offset:40960
    ds_read_b64_tr_b16 v[30:31], v229 offset:41984
    ds_read_b128 v[36:39], v218 offset:36864
    s_waitcnt lgkmcnt(6)
    v_mfma_f32_32x32x16_bf16 v[88:103], v[40:43], v[52:55], v[88:103]
    buffer_load_dwordx4 v214, s[20:23], s50 offen offset:2048 lds
    v_mfma_f32_32x32x16_bf16 v[104:119], v[44:47], v[52:55], v[104:119]
    buffer_load_dwordx4 v215, s[20:23], s50 offen offset:3072 lds
    s_waitcnt lgkmcnt(3)
    v_mfma_f32_32x32x16_bf16 v[56:71], v[24:27], v[32:35], v[56:71]
    ds_read_b64_tr_b16 v[40:41], v228 offset:45056
    ds_read_b64_tr_b16 v[42:43], v228 offset:46080
    ds_read_b128 v[48:51], v219 offset:32768
    s_waitcnt lgkmcnt(4)
    v_mfma_f32_32x32x16_bf16 v[72:87], v[28:31], v[32:35], v[72:87]
    ds_read_b64_tr_b16 v[44:45], v229 offset:45056
    ds_read_b64_tr_b16 v[46:47], v229 offset:46080
    ds_read_b128 v[52:55], v219 offset:36864
    s_waitcnt lgkmcnt(6)
    v_mfma_f32_32x32x16_bf16 v[88:103], v[24:27], v[36:39], v[88:103]
    s_add_u32 m0, s48, 131072
    s_add_u32 s96, s96, 1
    s_cmp_eq_u32 s96, 10
    s_cselect_b32 s96, 0, s96
    s_lshl_b32 s49, s96, 7
    s_add_u32 s49, s49, s97
    buffer_load_dwordx4 v208, s[16:19], s49 offen offset:0 lds
    v_mfma_f32_32x32x16_bf16 v[104:119], v[28:31], v[36:39], v[104:119]
    buffer_load_dwordx4 v209, s[16:19], s49 offen offset:1024 lds
    s_waitcnt lgkmcnt(3)
    v_mfma_f32_32x32x16_bf16 v[56:71], v[40:43], v[48:51], v[56:71]
    s_waitcnt vmcnt(11) lgkmcnt(0)
    s_barrier
    ds_read_b64_tr_b16 v[24:25], v230 offset:0
    ds_read_b64_tr_b16 v[26:27], v230 offset:1024
    ds_read_b128 v[32:35], v220 offset:0
    v_mfma_f32_32x32x16_bf16 v[72:87], v[44:47], v[48:51], v[72:87]
    ds_read_b64_tr_b16 v[28:29], v231 offset:0
    ds_read_b64_tr_b16 v[30:31], v231 offset:1024
    ds_read_b128 v[36:39], v220 offset:4096
    v_mfma_f32_32x32x16_bf16 v[88:103], v[40:43], v[52:55], v[88:103]
    buffer_load_dwordx4 v210, s[16:19], s49 offen offset:2048 lds
    v_mfma_f32_32x32x16_bf16 v[104:119], v[44:47], v[52:55], v[104:119]
    buffer_load_dwordx4 v211, s[16:19], s49 offen offset:3072 lds
    s_waitcnt lgkmcnt(3)
    v_mfma_f32_32x32x16_bf16 v[56:71], v[24:27], v[32:35], v[56:71]
    ds_read_b64_tr_b16 v[40:41], v230 offset:4096
    ds_read_b64_tr_b16 v[42:43], v230 offset:5120
    ds_read_b128 v[48:51], v221 offset:0
    s_waitcnt lgkmcnt(4)
    v_mfma_f32_32x32x16_bf16 v[72:87], v[28:31], v[32:35], v[72:87]
    ds_read_b64_tr_b16 v[44:45], v231 offset:4096
    ds_read_b64_tr_b16 v[46:47], v231 offset:5120
    ds_read_b128 v[52:55], v221 offset:4096
    s_waitcnt lgkmcnt(6)
    v_mfma_f32_32x32x16_bf16 v[88:103], v[24:27], v[36:39], v[88:103]
    s_add_u32 m0, s48, 147456
    s_mul_i32 s50, s96, 221184
    s_add_u32 s50, s50, s98
    buffer_load_dwordx4 v212, s[20:23], s50 offen offset:0 lds
    v_mfma_f32_32x32x16_bf16 v[104:119], v[28:31], v[36:39], v[104:119]
    buffer_load_dwordx4 v213, s[20:23], s50 offen offset:1024 lds
    s_waitcnt lgkmcnt(3)
    v_mfma_f32_32x32x16_bf16 v[56:71], v[40:43], v[48:51], v[56:71]
    ds_read_b64_tr_b16 v[24:25], v230 offset:8192
    ds_read_b64_tr_b16 v[26:27], v230 offset:9216
    ds_read_b128 v[32:35], v222 offset:0
    s_waitcnt lgkmcnt(4)
    v_mfma_f32_32x32x16_bf16 v[72:87], v[44:47], v[48:51], v[72:87]
    ds_read_b64_tr_b16 v[28:29], v231 offset:8192
    ds_read_b64_tr_b16 v[30:31], v231 offset:9216
    ds_read_b128 v[36:39], v222 offset:4096
    s_waitcnt lgkmcnt(6)
    v_mfma_f32_32x32x16_bf16 v[88:103], v[40:43], v[52:55], v[88:103]
    buffer_load_dwordx4 v214, s[20:23], s50 offen offset:2048 lds
    v_mfma_f32_32x32x16_bf16 v[104:119], v[44:47], v[52:55], v[104:119]
    buffer_load_dwordx4 v215, s[20:23], s50 offen offset:3072 lds
    s_waitcnt lgkmcnt(3)
    v_mfma_f32_32x32x16_bf16 v[56:71], v[24:27], v[32:35], v[56:71]
    ds_read_b64_tr_b16 v[40:41], v230 offset:12288
    ds_read_b64_tr_b16 v[42:43], v230 offset:13312
    ds_read_b128 v[48:51], v223 offset:0
    s_waitcnt lgkmcnt(4)
    v_mfma_f32_32x32x16_bf16 v[72:87], v[28:31], v[32:35], v[72:87]
    ds_read_b64_tr_b16 v[44:45], v231 offset:12288
    ds_read_b64_tr_b16 v[46:47], v231 offset:13312
    ds_read_b128 v[52:55], v223 offset:4096
    s_waitcnt lgkmcnt(6)
    v_mfma_f32_32x32x16_bf16 v[88:103], v[24:27], v[36:39], v[88:103]
    s_add_u32 s36, s36, 1
    s_cmp_eq_u32 s36, 3
    s_cselect_b32 s36, 0, s36
    s_mul_i32 s55, s36, 163840
    s_add_u32 s55, s55, s38
    s_add_u32 m0, s4, 0
    s_nop 0
    buffer_load_dwordx4 v120, s[8:11], s55 offen offset:0 lds
    buffer_load_dwordx2 v[6:7], v22, s[24:27], 0 offen sc1
    v_mfma_f32_32x32x16_bf16 v[104:119], v[28:31], v[36:39], v[104:119]
    buffer_load_dwordx4 v121, s[8:11], s55 offen offset:1024 lds
    s_waitcnt lgkmcnt(3)
    v_mfma_f32_32x32x16_bf16 v[56:71], v[40:43], v[48:51], v[56:71]
    s_waitcnt vmcnt(11) lgkmcnt(0)
    s_barrier
    ds_read_b64_tr_b16 v[24:25], v230 offset:32768
    ds_read_b64_tr_b16 v[26:27], v230 offset:33792
    ds_read_b128 v[32:35], v220 offset:32768
    v_mfma_f32_32x32x16_bf16 v[72:87], v[44:47], v[48:51], v[72:87]
    ds_read_b64_tr_b16 v[28:29], v231 offset:32768
    ds_read_b64_tr_b16 v[30:31], v231 offset:33792
    ds_read_b128 v[36:39], v220 offset:36864
    v_mfma_f32_32x32x16_bf16 v[88:103], v[40:43], v[52:55], v[88:103]
    buffer_load_dwordx4 v122, s[8:11], s55 offen offset:2048 lds
    v_mfma_f32_32x32x16_bf16 v[104:119], v[44:47], v[52:55], v[104:119]
    buffer_load_dwordx4 v123, s[8:11], s55 offen offset:3072 lds
    s_waitcnt lgkmcnt(3)
    v_mfma_f32_32x32x16_bf16 v[56:71], v[24:27], v[32:35], v[56:71]
    ds_read_b64_tr_b16 v[40:41], v230 offset:36864
    ds_read_b64_tr_b16 v[42:43], v230 offset:37888
    ds_read_b128 v[48:51], v221 offset:32768
    s_waitcnt lgkmcnt(4)
    v_mfma_f32_32x32x16_bf16 v[72:87], v[28:31], v[32:35], v[72:87]
    ds_read_b64_tr_b16 v[44:45], v231 offset:36864
    ds_read_b64_tr_b16 v[46:47], v231 offset:37888
    ds_read_b128 v[52:55], v221 offset:36864
    s_waitcnt lgkmcnt(6)
    v_mfma_f32_32x32x16_bf16 v[88:103], v[24:27], v[36:39], v[88:103]
    s_add_u32 m0, s4, 4096
    s_nop 0
    buffer_load_dwordx4 v124, s[8:11], s55 offen offset:0 lds
    v_mfma_f32_32x32x16_bf16 v[104:119], v[28:31], v[36:39], v[104:119]
    s_add_u32 s36, s36, 1
    s_cmp_eq_u32 s36, 3
    s_cselect_b32 s36, 0, s36
    s_mul_i32 s55, s36, 163840
    s_add_u32 s55, s55, s38
    s_add_u32 m0, s4, 20480
    s_nop 0
    buffer_load_dwordx4 v120, s[8:11], s55 offen offset:0 lds
    s_waitcnt lgkmcnt(3)
    v_mfma_f32_32x32x16_bf16 v[56:71], v[40:43], v[48:51], v[56:71]
    ds_read_b64_tr_b16 v[24:25], v230 offset:40960
    ds_read_b64_tr_b16 v[26:27], v230 offset:41984
    ds_read_b128 v[32:35], v222 offset:32768
    s_waitcnt lgkmcnt(4)
    v_mfma_f32_32x32x16_bf16 v[72:87], v[44:47], v[48:51], v[72:87]
    ds_read_b64_tr_b16 v[28:29], v231 offset:40960
    ds_read_b64_tr_b16 v[30:31], v231 offset:41984
    ds_read_b128 v[36:39], v222 offset:36864
    s_waitcnt lgkmcnt(6)
    v_mfma_f32_32x32x16_bf16 v[88:103], v[40:43], v[52:55], v[88:103]
    buffer_load_dwordx4 v121, s[8:11], s55 offen offset:1024 lds
    s_waitcnt vmcnt(6)
    s_mov_b32 s57, 0
L_spin_w2a:
    v_cmp_eq_u64 vcc, s[58:59], v[6:7]
    s_add_u32 s57, s57, 1
    s_cmp_eq_u64 vcc, exec
    s_cbranch_scc1 L_ok_w2a
    s_cmp_ge_u32 s57, 20000
    s_cbranch_scc1 L_ok_w2a
    s_sleep 4
    buffer_load_dwordx2 v[6:7], v22, s[24:27], 0 offen sc1
    s_waitcnt vmcnt(0)
    s_branch L_spin_w2a
L_ok_w2a:
    v_mfma_f32_32x32x16_bf16 v[104:119], v[44:47], v[52:55], v[104:119]
    buffer_load_dwordx4 v122, s[8:11], s55 offen offset:2048 lds
    s_waitcnt lgkmcnt(3)
    v_mfma_f32_32x32x16_bf16 v[56:71], v[24:27], v[32:35], v[56:71]
    ds_read_b64_tr_b16 v[40:41], v230 offset:45056
    ds_read_b64_tr_b16 v[42:43], v230 offset:46080
    ds_read_b128 v[48:51], v223 offset:32768
    s_waitcnt lgkmcnt(4)
    v_mfma_f32_32x32x16_bf16 v[72:87], v[28:31], v[32:35], v[72:87]
    ds_read_b64_tr_b16 v[44:45], v231 offset:45056
    ds_read_b64_tr_b16 v[46:47], v231 offset:46080
    ds_read_b128 v[52:55], v223 offset:36864
    s_waitcnt lgkmcnt(6)
    v_mfma_f32_32x32x16_bf16 v[88:103], v[24:27], v[36:39], v[88:103]
    buffer_load_dwordx4 v123, s[8:11], s55 offen offset:3072 lds
    v_mfma_f32_32x32x16_bf16 v[104:119], v[28:31], v[36:39], v[104:119]
    s_add_u32 m0, s4, 24576
    s_nop 0
    buffer_load_dwordx4 v124, s[8:11], s55 offen offset:0 lds
    s_waitcnt lgkmcnt(3)
    v_mfma_f32_32x32x16_bf16 v[56:71], v[40:43], v[48:51], v[56:71]
    s_waitcnt lgkmcnt(0)
    s_barrier
    ds_read_b64_tr_b16 v[24:25], v232 offset:0
    ds_read_b64_tr_b16 v[26:27], v232 offset:1024
    ds_read_b128 v[32:35], v224 offset:0
    v_mfma_f32_32x32x16_bf16 v[72:87], v[44:47], v[48:51], v[72:87]
    ds_read_b64_tr_b16 v[28:29], v233 offset:0
    ds_read_b64_tr_b16 v[30:31], v233 offset:1024
    ds_read_b128 v[36:39], v224 offset:4096
    v_mfma_f32_32x32x16_bf16 v[88:103], v[40:43], v[52:55], v[88:103]
    s_add_u32 s36, s36, 1
    s_cmp_eq_u32 s36, 3
    s_cselect_b32 s36, 0, s36
    s_mul_i32 s55, s36, 163840
    s_add_u32 s55, s55, s38
    s_add_u32 m0, s4, 40960
    s_nop 0
    buffer_load_dwordx4 v120, s[8:11], s55 offen offset:0 lds
    v_mfma_f32_32x32x16_bf16 v[104:119], v[44:47], v[52:55], v[104:119]
    buffer_load_dwordx4 v121, s[8:11], s55 offen offset:1024 lds
    s_waitcnt lgkmcnt(3)
    v_mfma_f32_32x32x16_bf16 v[56:71], v[24:27], v[32:35], v[56:71]
    ds_read_b64_tr_b16 v[40:41], v232 offset:4096
    ds_read_b64_tr_b16 v[42:43], v232 offset:5120
    ds_read_b128 v[48:51], v225 offset:0
    s_waitcnt lgkmcnt(4)
    v_mfma_f32_32x32x16_bf16 v[72:87], v[28:31], v[32:35], v[72:87]
    ds_read_b64_tr_b16 v[44:45], v233 offset:4096
    ds_read_b64_tr_b16 v[46:47], v233 offset:5120
    ds_read_b128 v[52:55], v225 offset:4096
    s_waitcnt lgkmcnt(6)
    v_mfma_f32_32x32x16_bf16 v[88:103], v[24:27], v[36:39], v[88:103]
    buffer_load_dwordx4 v122, s[8:11], s55 offen offset:2048 lds
    buffer_load_dwordx4 v123, s[8:11], s55 offen offset:3072 lds
    v_mfma_f32_32x32x16_bf16 v[104:119], v[28:31], v[36:39], v[104:119]
    s_add_u32 m0, s4, 45056
    s_nop 0
    buffer_load_dwordx4 v124, s[8:11], s55 offen offset:0 lds
    s_waitcnt lgkmcnt(3)
    v_mfma_f32_32x32x16_bf16 v[56:71], v[40:43], v[48:51], v[56:71]
    ds_read_b64_tr_b16 v[24:25], v232 offset:8192
    ds_read_b64_tr_b16 v[26:27], v232 offset:9216
    ds_read_b128 v[32:35], v226 offset:0
    s_waitcnt lgkmcnt(4)
    v_mfma_f32_32x32x16_bf16 v[72:87], v[44:47], v[48:51], v[72:87]
    ds_read_b64_tr_b16 v[28:29], v233 offset:8192
    ds_read_b64_tr_b16 v[30:31], v233 offset:9216
    ds_read_b128 v[36:39], v226 offset:4096
    s_waitcnt lgkmcnt(6)
    v_mfma_f32_32x32x16_bf16 v[88:103], v[40:43], v[52:55], v[88:103]
    s_add_u32 s6, s6, 1
    s_cmp_eq_u32 s6, 11
    s_cselect_b32 s6, 0, s6
    s_mul_i32 s55, s6, 163840
    s_add_u32 s55, s55, s5
    s_cmp_eq_u32 s6, s99
    s_cselect_b32 s55, 1073741824, s55
    buffer_load_dwordx4 a[60:63], v10, s[24:27], s55 offen offset:0 sc1
    v_mfma_f32_32x32x16_bf16 v[104:119], v[44:47], v[52:55], v[104:119]
    buffer_load_dwordx4 a[64:67], v10, s[24:27], s55 offen offset:1024 sc1
    s_waitcnt lgkmcnt(3)
    v_mfma_f32_32x32x16_bf16 v[56:71], v[24:27], v[32:35], v[56:71]
    ds_read_b64_tr_b16 v[40:41], v232 offset:12288
    ds_read_b64_tr_b16 v[42:43], v232 offset:13312
    ds_read_b128 v[48:51], v227 offset:0
    s_waitcnt lgkmcnt(4)
    v_mfma_f32_32x32x16_bf16 v[72:87], v[28:31], v[32:35], v[72:87]
    ds_read_b64_tr_b16 v[44:45], v233 offset:12288
    ds_read_b64_tr_b16 v[46:47], v233 offset:13312
    ds_read_b128 v[52:55], v227 offset:4096
    s_waitcnt lgkmcnt(6)
    v_mfma_f32_32x32x16_bf16 v[88:103], v[24:27], v[36:39], v[88:103]
    buffer_load_dwordx4 a[68:71], v10, s[24:27], s55 offen offset:2048 sc1
    v_mfma_f32_32x32x16_bf16 v[104:119], v[28:31], v[36:39], v[104:119]
    buffer_load_dwordx4 a[72:75], v10, s[24:27], s55 offen offset:3072 sc1
    s_waitcnt lgkmcnt(3)
    v_mfma_f32_32x32x16_bf16 v[56:71], v[40:43], v[48:51], v[56:71]
    s_waitcnt lgkmcnt(1)
    v_mfma_f32_32x32x16_bf16 v[72:87], v[44:47], v[48:51], v[72:87]
    s_waitcnt lgkmcnt(0)
    v_mfma_f32_32x32x16_bf16 v[88:103], v[40:43], v[52:55], v[88:103]
    buffer_load_dwordx4 a[76:79], v11, s[24:27], s55 offen sc1
    v_cmp_ne_u64 vcc, v[4:5], v[132:133]
    s_or_b32 s13, vcc_lo, vcc_hi
    v_mfma_f32_32x32x16_bf16 v[104:119], v[44:47], v[52:55], v[104:119]
    s_add_u32 s6, s6, 1
    s_cmp_eq_u32 s6, 11
    s_cselect_b32 s6, 0, s6
    s_mul_i32 s55, s6, 163840
    s_add_u32 s55, s55, s5
    s_cmp_eq_u32 s6, s99
    s_cselect_b32 s55, 1073741824, s55
    buffer_load_dwordx4 a[80:83], v10, s[24:27], s55 offen offset:0 sc1
    s_barrier
    s_nop 6
    s_cmp_lg_u32 s13, 0
    s_cbranch_scc1 L_epi_far
    v_cvt_pk_bf16_f32 v176, v56, v57
    v_cvt_pk_bf16_f32 v177, v58, v59
    v_cvt_pk_bf16_f32 v178, v60, v61
    v_cvt_pk_bf16_f32 v179, v62, v63
    v_pk_max_i16 v176, v176, 0
    v_pk_max_i16 v177, v177, 0
    v_pk_max_i16 v178, v178, 0
    v_pk_max_i16 v179, v179, 0
    buffer_store_dwordx4 v[176:179], v8, s[24:27], s51 offen offset:0
    v_cvt_pk_bf16_f32 v180, v64, v65
    v_cvt_pk_bf16_f32 v181, v66, v67
    v_cvt_pk_bf16_f32 v182, v68, v69
    v_cvt_pk_bf16_f32 v183, v70, v71
    v_pk_max_i16 v180, v180, 0
    v_pk_max_i16 v181, v181, 0
    v_pk_max_i16 v182, v182, 0
    v_pk_max_i16 v183, v183, 0
    buffer_store_dwordx4 v[180:183], v8, s[24:27], s51 offen offset:512
    v_cvt_pk_bf16_f32 v184, v72, v73
    v_cvt_pk_bf16_f32 v185, v74, v75
    v_cvt_pk_bf16_f32 v186, v76, v77
    v_cvt_pk_bf16_f32 v187, v78, v79
    v_pk_max_i16 v184, v184, 0
    v_pk_max_i16 v185, v185, 0
    v_pk_max_i16 v186, v186, 0
    v_pk_max_i16 v187, v187, 0
    buffer_store_dwordx4 v[184:187], v8, s[24:27], s52 offen offset:0
    v_cvt_pk_bf16_f32 v188, v80, v81
    v_cvt_pk_bf16_f32 v189, v82, v83
    v_cvt_pk_bf16_f32 v190, v84, v85
    v_cvt_pk_bf16_f32 v191, v86, v87
    v_pk_max_i16 v188, v188, 0
    v_pk_max_i16 v189, v189, 0
    v_pk_max_i16 v190, v190, 0
    v_pk_max_i16 v191, v191, 0
    buffer_store_dwordx4 v[188:191], v8, s[24:27], s52 offen offset:512
    v_cvt_pk_bf16_f32 v192, v88, v89
    v_cvt_pk_bf16_f32 v193, v90, v91
    v_cvt_pk_bf16_f32 v194, v92, v93
    v_cvt_pk_bf16_f32 v195, v94, v95
    v_pk_max_i16 v192, v192, 0
    v_pk_max_i16 v193, v193, 0
    v_pk_max_i16 v194, v194, 0
    v_pk_max_i16 v195, v195, 0
    buffer_store_dwordx4 v[192:195], v8, s[24:27], s51 offen offset:2048
    v_cvt_pk_bf16_f32 v196, v96, v97
    v_cvt_pk_bf16_f32 v197, v98, v99
    v_cvt_pk_bf16_f32 v198, v100, v101
    v_cvt_pk_bf16_f32 v199, v102, v103
    v_pk_max_i16 v196, v196, 0
    v_pk_max_i16 v197, v197, 0
    v_pk_max_i16 v198, v198, 0
    v_pk_max_i16 v199, v199, 0
    buffer_store_dwordx4 v[196:199], v8, s[24:27], s51 offen offset:2560
    v_cvt_pk_bf16_f32 v200, v104, v105
    v_cvt_pk_bf16_f32 v201, v106, v107
    v_cvt_pk_bf16_f32 v202, v108, v109
    v_cvt_pk_bf16_f32 v203, v110, v111
    v_pk_max_i16 v200, v200, 0
    v_pk_max_i16 v201, v201, 0
    v_pk_max_i16 v202, v202, 0
    v_pk_max_i16 v203, v203, 0
    buffer_store_dwordx4 v[200:203], v8, s[24:27], s52 offen offset:2048
    v_cvt_pk_bf16_f32 v204, v112, v113
    v_cvt_pk_bf16_f32 v205, v114, v115
    v_cvt_pk_bf16_f32 v206, v116, v117
    v_cvt_pk_bf16_f32 v207, v118, v119
    v_pk_max_i16 v204, v204, 0
    v_pk_max_i16 v205, v205, 0
    v_pk_max_i16 v206, v206, 0
    v_pk_max_i16 v207, v207, 0
    buffer_store_dwordx4 v[204:207], v8, s[24:27], s52 offen offset:2560
    s_branch L_epi_done
L_epi_far:
    v_cvt_pk_bf16_f32 v176, v56, v57
    v_cvt_pk_bf16_f32 v177, v58, v59
    v_cvt_pk_bf16_f32 v178, v60, v61
    v_cvt_pk_bf16_f32 v179, v62, v63
    v_pk_max_i16 v176, v176, 0
    v_pk_max_i16 v177, v177, 0
    v_pk_max_i16 v178, v178, 0
    v_pk_max_i16 v179, v179, 0
    buffer_store_dwordx4 v[176:179], v8, s[24:27], s51 offen offset:0 sc1
    v_cvt_pk_bf16_f32 v180, v64, v65
    v_cvt_pk_bf16_f32 v181, v66, v67
    v_cvt_pk_bf16_f32 v182, v68, v69
    v_cvt_pk_bf16_f32 v183, v70, v71
    v_pk_max_i16 v180, v180, 0
    v_pk_max_i16 v181, v181, 0
    v_pk_max_i16 v182, v182, 0
    v_pk_max_i16 v183, v183, 0
    buffer_store_dwordx4 v[180:183], v8, s[24:27], s51 offen offset:512 sc1
    v_cvt_pk_bf16_f32 v184, v72, v73
    v_cvt_pk_bf16_f32 v185, v74, v75
    v_cvt_pk_bf16_f32 v186, v76, v77
    v_cvt_pk_bf16_f32 v187, v78, v79
    v_pk_max_i16 v184, v184, 0
    v_pk_max_i16 v185, v185, 0
    v_pk_max_i16 v186, v186, 0
    v_pk_max_i16 v187, v187, 0
    buffer_store_dwordx4 v[184:187], v8, s[24:27], s52 offen offset:0 sc1
    v_cvt_pk_bf16_f32 v188, v80, v81
    v_cvt_pk_bf16_f32 v189, v82, v83
    v_cvt_pk_bf16_f32 v190, v84, v85
    v_cvt_pk_bf16_f32 v191, v86, v87
    v_pk_max_i16 v188, v188, 0
    v_pk_max_i16 v189, v189, 0
    v_pk_max_i16 v190, v190, 0
    v_pk_max_i16 v191, v191, 0
    buffer_store_dwordx4 v[188:191], v8, s[24:27], s52 offen offset:512 sc1
    v_cvt_pk_bf16_f32 v192, v88, v89
    v_cvt_pk_bf16_f32 v193, v90, v91
    v_cvt_pk_bf16_f32 v194, v92, v93
    v_cvt_pk_bf16_f32 v195, v94, v95
    v_pk_max_i16 v192, v192, 0
    v_pk_max_i16 v193, v193, 0
    v_pk_max_i16 v194, v194, 0
    v_pk_max_i16 v195, v195, 0
    buffer_store_dwordx4 v[192:195], v8, s[24:27], s51 offen offset:2048 sc1
    v_cvt_pk_bf16_f32 v196, v96, v97
    v_cvt_pk_bf16_f32 v197, v98, v99
    v_cvt_pk_bf16_f32 v198, v100, v101
    v_cvt_pk_bf16_f32 v199, v102, v103
    v_pk_max_i16 v196, v196, 0
    v_pk_max_i16 v197, v197, 0
    v_pk_max_i16 v198, v198, 0
    v_pk_max_i16 v199, v199, 0
    buffer_store_dwordx4 v[196:199], v8, s[24:27], s51 offen offset:2560 sc1
    v_cvt_pk_bf16_f32 v200, v104, v105
    v_cvt_pk_bf16_f32 v201, v106, v107
    v_cvt_pk_bf16_f32 v202, v108, v109
    v_cvt_pk_bf16_f32 v203, v110, v111
    v_pk_max_i16 v200, v200, 0
    v_pk_max_i16 v201, v201, 0
    v_pk_max_i16 v202, v202, 0
    v_pk_max_i16 v203, v203, 0
    buffer_store_dwordx4 v[200:203], v8, s[24:27], s52 offen offset:2048 sc1
    v_cvt_pk_bf16_f32 v204, v112, v113
    v_cvt_pk_bf16_f32 v205, v114, v115
    v_cvt_pk_bf16_f32 v206, v116, v117
    v_cvt_pk_bf16_f32 v207, v118, v119
    v_pk_max_i16 v204, v204, 0
    v_pk_max_i16 v205, v205, 0
    v_pk_max_i16 v206, v206, 0
    v_pk_max_i16 v207, v207, 0
    buffer_store_dwordx4 v[204:207], v8, s[24:27], s52 offen offset:2560 sc1
L_epi_done:
    buffer_load_dwordx4 a[84:87], v10, s[24:27], s55 offen offset:1024 sc1
    s_waitcnt vmcnt(25)
    ds_read_b64_tr_b16 a[0:1], v125 offset:0
    ds_read_b64_tr_b16 a[2:3], v125 offset:1280
    ds_read_b64_tr_b16 a[4:5], v125 offset:32
    buffer_load_dwordx4 a[88:91], v10, s[24:27], s55 offen offset:2048 sc1
    ds_read_b64_tr_b16 a[6:7], v125 offset:1312
    ds_read_b64_tr_b16 a[8:9], v125 offset:64
    ds_read_b64_tr_b16 a[10:11], v125 offset:1344
    buffer_load_dwordx4 a[92:95], v10, s[24:27], s55 offen offset:3072 sc1
    ds_read_b64_tr_b16 a[12:13], v125 offset:96
    ds_read_b64_tr_b16 a[14:15], v125 offset:1376
    ds_read_b64_tr_b16 a[16:17], v125 offset:128
    buffer_load_dwordx4 a[96:99], v11, s[24:27], s55 offen sc1
    ds_read_b64_tr_b16 a[18:19], v125 offset:1408
    s_waitcnt vmcnt(23)
    ds_read_b64_tr_b16 a[20:21], v125 offset:20480
    ds_read_b64_tr_b16 a[22:23], v125 offset:21760
    s_waitcnt vmcnt(4)
    s_cmp_lg_u32 s13, 0
    s_cbranch_scc1 L_fl_far
    buffer_store_dwordx2 v[2:3], v23, s[24:27], s100 offen
    s_branch L_fl_done
L_fl_far:
    buffer_store_dwordx2 v[2:3], v23, s[24:27], s100 offen sc1
L_fl_done:
    s_barrier
    s_add_u32 s6, s6, 1
    s_cmp_eq_u32 s6, 11
    s_cselect_b32 s6, 0, s6
    s_mul_i32 s55, s6, 163840
    s_add_u32 s55, s55, s5
    s_cmp_eq_u32 s6, s99
    s_cselect_b32 s55, 1073741824, s55
    buffer_load_dwordx4 a[100:103], v10, s[24:27], s55 offen offset:0 sc1
    buffer_load_dwordx4 a[104:107], v10, s[24:27], s55 offen offset:1024 sc1
    buffer_load_dwordx4 a[108:111], v10, s[24:27], s55 offen offset:2048 sc1
    buffer_load_dwordx4 a[112:115], v10, s[24:27], s55 offen offset:3072 sc1
    buffer_load_dwordx4 a[116:119], v11, s[24:27], s55 offen sc1
    s_add_u32 s6, s6, 1
    s_cmp_eq_u32 s6, 11
    s_cselect_b32 s6, 0, s6
    s_mul_i32 s55, s6, 163840
    s_add_u32 s55, s55, s5
    s_cmp_eq_u32 s6, s99
    s_cselect_b32 s55, 1073741824, s55
    buffer_load_dwordx4 a[120:123], v10, s[24:27], s55 offen offset:0 sc1
    buffer_load_dwordx4 a[124:127], v10, s[24:27], s55 offen offset:1024 sc1
    buffer_load_dwordx4 a[128:131], v10, s[24:27], s55 offen offset:2048 sc1
    buffer_load_dwordx4 a[132:135], v10, s[24:27], s55 offen offset:3072 sc1
    buffer_load_dwordx4 a[136:139], v11, s[24:27], s55 offen sc1
    s_add_u32 s6, s6, 1
    s_cmp_eq_u32 s6, 11
    s_cselect_b32 s6, 0, s6
    s_mul_i32 s55, s6, 163840
    s_add_u32 s55, s55, s5
    s_cmp_eq_u32 s6, s99
    s_cselect_b32 s55, 1073741824, s55
    buffer_load_dwordx4 a[140:143], v10, s[24:27], s55 offen offset:0 sc1
    buffer_load_dwordx4 a[144:147], v10, s[24:27], s55 offen offset:1024 sc1
    buffer_load_dwordx4 a[148:151], v10, s[24:27], s55 offen offset:2048 sc1
    buffer_load_dwordx4 a[152:155], v10, s[24:27], s55 offen offset:3072 sc1
    buffer_load_dwordx4 a[156:159], v11, s[24:27], s55 offen sc1
    s_add_u32 s6, s6, 1
    s_cmp_eq_u32 s6, 11
    s_cselect_b32 s6, 0, s6
    s_mul_i32 s55, s6, 163840
    s_add_u32 s55, s55, s5
    s_cmp_eq_u32 s6, s99
    s_cselect_b32 s55, 1073741824, s55
    buffer_load_dwordx4 a[160:163], v10, s[24:27], s55 offen offset:0 sc1
    buffer_load_dwordx4 a[164:167], v10, s[24:27], s55 offen offset:1024 sc1
    buffer_load_dwordx4 a[168:171], v10, s[24:27], s55 offen offset:2048 sc1
    buffer_load_dwordx4 a[172:175], v10, s[24:27], s55 offen offset:3072 sc1
    buffer_load_dwordx4 a[176:179], v11, s[24:27], s55 offen sc1
    s_add_u32 s6, s6, 1
    s_cmp_eq_u32 s6, 11
    s_cselect_b32 s6, 0, s6
    s_mul_i32 s55, s6, 163840
    s_add_u32 s55, s55, s5
    s_cmp_eq_u32 s6, s99
    s_cselect_b32 s55, 1073741824, s55
    buffer_load_dwordx4 a[180:183], v10, s[24:27], s55 offen offset:0 sc1
    buffer_load_dwordx4 a[184:187], v10, s[24:27], s55 offen offset:1024 sc1
    buffer_load_dwordx4 a[188:191], v10, s[24:27], s55 offen offset:2048 sc1
    buffer_load_dwordx4 a[192:195], v10, s[24:27], s55 offen offset:3072 sc1
    buffer_load_dwordx4 a[196:199], v11, s[24:27], s55 offen sc1
    s_add_u32 s6, s6, 1
    s_cmp_eq_u32 s6, 11
    s_cselect_b32 s6, 0, s6
    s_mul_i32 s55, s6, 163840
    s_add_u32 s55, s55, s5
    s_cmp_eq_u32 s6, s99
    s_cselect_b32 s55, 1073741824, s55
    buffer_load_dwordx4 a[200:203], v10, s[24:27], s55 offen offset:0 sc1
    buffer_load_dwordx4 a[204:207], v10, s[24:27], s55 offen offset:1024 sc1
    buffer_load_dwordx4 a[208:211], v10, s[24:27], s55 offen offset:2048 sc1
    buffer_load_dwordx4 a[212:215], v10, s[24:27], s55 offen offset:3072 sc1
    buffer_load_dwordx4 a[216:219], v11, s[24:27], s55 offen sc1
    s_add_u32 s6, s6, 1
    s_cmp_eq_u32 s6, 11
    s_cselect_b32 s6, 0, s6
    s_mul_i32 s55, s6, 163840
    s_add_u32 s55, s55, s5
    s_cmp_eq_u32 s6, s99
    s_cselect_b32 s55, 1073741824, s55
    buffer_load_dwordx4 a[220:223], v10, s[24:27], s55 offen offset:0 sc1
    buffer_load_dwordx4 a[224:227], v10, s[24:27], s55 offen offset:1024 sc1
    buffer_load_dwordx4 a[228:231], v10, s[24:27], s55 offen offset:2048 sc1
    buffer_load_dwordx4 a[232:235], v10, s[24:27], s55 offen offset:3072 sc1
    buffer_load_dwordx4 a[236:239], v11, s[24:27], s55 offen sc1
    s_add_u32 s6, s6, 1
    s_cmp_eq_u32 s6, 11
    s_cselect_b32 s6, 0, s6
    s_mul_i32 s55, s6, 163840
    s_add_u32 s55, s55, s5
    s_cmp_eq_u32 s6, s99
    s_cselect_b32 s55, 1073741824, s55
    buffer_load_dwordx4 v[136:139], v10, s[24:27], s55 offen offset:0 sc1
    buffer_load_dwordx4 v[140:143], v10, s[24:27], s55 offen offset:1024 sc1
    buffer_load_dwordx4 v[144:147], v10, s[24:27], s55 offen offset:2048 sc1
    buffer_load_dwordx4 v[148:151], v10, s[24:27], s55 offen offset:3072 sc1
    buffer_load_dwordx4 v[152:155], v11, s[24:27], s55 offen sc1
    s_add_u32 s6, s6, 1
    s_cmp_eq_u32 s6, 11
    s_cselect_b32 s6, 0, s6
    s_mul_i32 s55, s6, 163840
    s_add_u32 s55, s55, s5
    s_cmp_eq_u32 s6, s99
    s_cselect_b32 s55, 1073741824, s55
    buffer_load_dwordx4 v[156:159], v10, s[24:27], s55 offen offset:0 sc1
    buffer_load_dwordx4 v[160:163], v10, s[24:27], s55 offen offset:1024 sc1
    buffer_load_dwordx4 v[164:167], v10, s[24:27], s55 offen offset:2048 sc1
    buffer_load_dwordx4 v[168:171], v10, s[24:27], s55 offen offset:3072 sc1
    buffer_load_dwordx4 v[172:175], v11, s[24:27], s55 offen sc1
    s_branch L_join
L_repack:
    s_sub_u32 s42, s41, 28
    s_lshl_b32 s42, s42, 3
    s_add_u32 s42, s42, s40
    s_lshl_b32 s42, s42, 2
    s_add_u32 s42, s42, s3
    s_mul_i32 s48, s3, 16384
    v_lshrrev_b32 v2, 3, v1
    v_mul_u32_u24 v2, 1280, v2
    v_and_b32 v3, 7, v1
    v_bfe_u32 v4, v1, 4, 2
    v_lshlrev_b32 v4, 1, v4
    v_xor_b32 v3, v3, v4
    v_lshl_add_u32 v2, v3, 4, v2
    v_add_u32 v208, 0, v2
    v_add_u32 v209, 9216, v2
    v_add_u32 v210, 18432, v2
    v_add_u32 v211, 27648, v2
    s_waitcnt lgkmcnt(0)
    s_mov_b32 s32, s12
    s_mov_b32 s33, s13
    s_mov_b32 s34, 256
    s_mov_b32 s35, 0x00020000
    s_cmp_lg_u32 s42, 124
    s_cbranch_scc1 L_nononce
    s_memrealtime s[58:59]
    s_waitcnt lgkmcnt(0)
    s_or_b32 s59, s59, 0x40000000
    v_mov_b32 v2, s58
    v_mov_b32 v3, s59
    v_lshlrev_b32 v4, 24, v1
    buffer_store_dwordx2 v[2:3], v4, s[32:35], 0 offen sc1
L_nononce:
    s_getreg_b32 s12, hwreg(HW_REG_XCC_ID)
    s_and_b32 s12, s12, 15
    s_mov_b32 s28, s10
    s_mov_b32 s29, s11
    s_mov_b32 s30, 2621440
    s_mov_b32 s31, 0x00020000
    s_mov_b32 s10, 2211840
    s_mov_b32 s11, 0x00020000
    s_add_u32 s44, s42, 0
    s_mul_i32 s45, s44, 205
    s_lshr_b32 s45, s45, 11
    s_mul_i32 s46, s45, 10
    s_sub_u32 s46, s44, s46
    s_mul_i32 s45, s45, 40960
    s_lshl_b32 s46, s46, 7
    s_add_u32 s45, s45, s46
    s_add_u32 s45, s45, 491520
    s_cmp_ge_u32 s44, 420
    s_cselect_b32 s45, 1073741824, s45
    s_add_u32 m0, s48, 0
    s_nop 0
    buffer_load_dwordx4 v208, s[8:11], s45 offen offset:0 lds
    buffer_load_dwordx4 v209, s[8:11], s45 offen offset:1024 lds
    buffer_load_dwordx4 v210, s[8:11], s45 offen offset:2048 lds
    buffer_load_dwordx4 v211, s[8:11], s45 offen offset:3072 lds
    s_add_u32 s44, s42, 128
    s_mul_i32 s45, s44, 205
    s_lshr_b32 s45, s45, 11
    s_mul_i32 s46, s45, 10
    s_sub_u32 s46, s44, s46
    s_mul_i32 s45, s45, 40960
    s_lshl_b32 s46, s46, 7
    s_add_u32 s45, s45, s46
    s_add_u32 s45, s45, 491520
    s_cmp_ge_u32 s44, 420
    s_cselect_b32 s45, 1073741824, s45
    s_add_u32 m0, s48, 4096
    s_nop 0
    buffer_load_dwordx4 v208, s[8:11], s45 offen offset:0 lds
    buffer_load_dwordx4 v209, s[8:11], s45 offen offset:1024 lds
    buffer_load_dwordx4 v210, s[8:11], s45 offen offset:2048 lds
    buffer_load_dwordx4 v211, s[8:11], s45 offen offset:3072 lds
    s_add_u32 s44, s42, 256
    s_mul_i32 s45, s44, 205
    s_lshr_b32 s45, s45, 11
    s_mul_i32 s46, s45, 10
    s_sub_u32 s46, s44, s46
    s_mul_i32 s45, s45, 40960
    s_lshl_b32 s46, s46, 7
    s_add_u32 s45, s45, s46
    s_add_u32 s45, s45, 491520
    s_cmp_ge_u32 s44, 420
    s_cselect_b32 s45, 1073741824, s45
    s_add_u32 m0, s48, 8192
    s_nop 0
    buffer_load_dwordx4 v208, s[8:11], s45 offen offset:0 lds
    buffer_load_dwordx4 v209, s[8:11], s45 offen offset:1024 lds
    buffer_load_dwordx4 v210, s[8:11], s45 offen offset:2048 lds
    buffer_load_dwordx4 v211, s[8:11], s45 offen offset:3072 lds
    s_add_u32 s44, s42, 384
    s_mul_i32 s45, s44, 205
    s_lshr_b32 s45, s45, 11
    s_mul_i32 s46, s45, 10
    s_sub_u32 s46, s44, s46
    s_mul_i32 s45, s45, 40960
    s_lshl_b32 s46, s46, 7
    s_add_u32 s45, s45, s46
    s_add_u32 s45, s45, 491520
    s_cmp_ge_u32 s44, 420
    s_cselect_b32 s45, 1073741824, s45
    s_add_u32 m0, s48, 12288
    s_nop 0
    buffer_load_dwordx4 v208, s[8:11], s45 offen offset:0 lds
    buffer_load_dwordx4 v209, s[8:11], s45 offen offset:1024 lds
    buffer_load_dwordx4 v210, s[8:11], s45 offen offset:2048 lds
    buffer_load_dwordx4 v211, s[8:11], s45 offen offset:3072 lds
    s_mov_b32 s24, s14
    s_mov_b32 s25, s15
    s_mov_b32 s26, 12582912
    s_mov_b32 s27, 0x00020000
    s_lshl_b32 s14, s41, 2
    s_add_u32 s14, s14, s3
    s_mul_i32 s14, s14, 3840
    v_lshrrev_b32 v128, 3, v1
    v_lshlrev_b32 v128, 7, v128
    buffer_load_dword v129, v128, s[8:11], s14 offen
    s_add_u32 s14, s14, 1024
    buffer_load_dword v129, v128, s[8:11], s14 offen
    s_add_u32 s14, s14, 1024
    buffer_load_dword v129, v128, s[8:11], s14 offen
    s_add_u32 s14, s14, 1024
    buffer_load_dword v129, v128, s[8:11], s14 offen
    s_lshl_b32 s62, s41, 2
    s_add_u32 s62, s62, s3
    s_lshl_b32 s62, s62, 6
    s_min_u32 s44, s62, L_codeend-L_pc
    s_load_dword s63, s[60:61], s44
    s_add_u32 s62, s62, 8192
    s_min_u32 s44, s62, L_codeend-L_pc
    s_load_dword s63, s[60:61], s44
    s_add_u32 s62, s62, 8192
    s_min_u32 s44, s62, L_codeend-L_pc
    s_load_dword s63, s[60:61], s44
    s_add_u32 s62, s62, 8192
    v_lshrrev_b32 v2, 5, v1
    v_bfe_u32 v3, v1, 4, 1
    v_bfe_u32 v4, v1, 2, 2
    v_lshlrev_b32 v2, 4, v2
    v_lshl_add_u32 v2, v3, 2, v2
    v_add_u32 v2, v2, v4
    v_lshlrev_b32 v2, 7, v2
    v_and_b32 v5, 1, v1
    v_lshl_add_u32 v2, v5, 3, v2
    v_add_u32 v2, s48, v2
    v_lshrrev_b32 v4, 1, v4
    v_lshl_add_u32 v3, v3, 1, v4
    v_lshlrev_b32 v3, 1, v3
    v_bfe_u32 v5, v1, 1, 1
    v_xor_b32 v6, 0, v3
    v_or_b32 v6, v6, v5
    v_lshl_add_u32 v212, v6, 4, v2
    v_xor_b32 v6, 2, v3
    v_or_b32 v6, v6, v5
    v_lshl_add_u32 v213, v6, 4, v2
    v_xor_b32 v6, 4, v3
    v_or_b32 v6, v6, v5
    v_lshl_add_u32 v214, v6, 4, v2
    v_xor_b32 v6, 6, v3
    v_or_b32 v6, v6, v5
    v_lshl_add_u32 v215, v6, 4, v2
    s_mov_b32 s0, 0
    s_lshl_b32 s53, s40, 2
    s_lshr_b32 s44, s41, 3
    s_add_u32 s53, s53, s44
    s_and_b32 s54, s41, 7
    s_mul_i32 s38, s3, 40960
    s_mul_i32 s44, s54, 160
    s_add_u32 s38, s38, s44
    s_mul_i32 s4, s3, 5120
    s_mul_i32 s5, s3, 40960
    s_mul_i32 s44, s54, 5120
    s_add_u32 s5, s5, s44
    s_add_u32 s5, s5, 7340032
    s_mul_i32 s39, s53, 54
    s_add_u32 s39, s39, s3
    s_lshl_b32 s39, s39, 12
    s_cmp_ge_u32 s3, 2
    s_cselect_b32 s99, 10, 99
    s_and_b32 s44, s53, 3
    s_lshl_b32 s45, s44, 1
    s_add_u32 s36, s45, s54
    s_cmp_ge_u32 s36, 3
    s_cselect_b32 s45, 3, 0
    s_sub_u32 s36, s36, s45
    s_cmp_ge_u32 s36, 3
    s_cselect_b32 s45, 3, 0
    s_sub_u32 s36, s36, s45
    s_cmp_ge_u32 s36, 3
    s_cselect_b32 s45, 3, 0
    s_sub_u32 s36, s36, s45
    s_cmp_ge_u32 s36, 3
    s_cselect_b32 s45, 3, 0
    s_sub_u32 s36, s36, s45
    s_lshl_b32 s44, s44, 1
    s_add_u32 s6, s44, s54
    s_cmp_ge_u32 s6, 11
    s_cselect_b32 s45, 11, 0
    s_sub_u32 s6, s6, s45
    s_mov_b32 s37, s36
    s_mov_b32 s7, s6
    v_lshlrev_b32 v10, 4, v1
    v_add_u32 v11, 4096, v10
    s_add_u32 s44, s3, 0
    s_and_b32 s44, s44, 3
    s_lshl_b32 s45, s44, 10
    v_add_u32 v12, s45, v10
    s_add_u32 s44, s3, 1
    s_and_b32 s44, s44, 3
    s_lshl_b32 s45, s44, 10
    v_add_u32 v13, s45, v10
    s_mul_i32 s45, s44, 15360
    s_add_u32 s45, s45, 0
    v_add_u32 v16, s45, v10
    s_add_u32 s44, s3, 2
    s_and_b32 s44, s44, 3
    s_lshl_b32 s45, s44, 10
    v_add_u32 v14, s45, v10
    s_mul_i32 s45, s44, 15360
    s_add_u32 s45, s45, 5120
    v_add_u32 v17, s45, v10
    s_add_u32 s44, s3, 3
    s_and_b32 s44, s44, 3
    s_lshl_b32 s45, s44, 10
    v_add_u32 v15, s45, v10
    s_mul_i32 s45, s44, 15360
    s_add_u32 s45, s45, 10240
    v_add_u32 v18, s45, v10
    s_mul_i32 s45, s3, 15360
    v_add_u32 v19, s45, v10
    v_and_b32 v2, 15, v1
    v_mul_u32_u24 v2, 1280, v2
    v_lshrrev_b32 v3, 4, v1
    v_lshl_add_u32 v20, v3, 3, v2
    s_lshl_b32 s44, s53, 2
    s_add_u32 s44, s44, s3
    s_mul_i32 s101, s44, 20480
    s_mul_i32 s45, s54, 160
    s_add_u32 s101, s101, s45
    v_min_u32 v2, 13, v1
    s_lshr_b32 s45, s3, 1
    v_lshl_add_u32 v2, v2, 1, s45
    v_min_u32 v2, 26, v2
    s_lshl_b32 s44, s53, 12
    s_add_u32 s44, s44, 10485760
    v_lshl_add_u32 v21, v2, 7, s44
    v_min_u32 v2, 7, v1
    s_lshl_b32 s44, s0, 10
    s_add_u32 s44, s44, 10878976
    v_lshl_add_u32 v134, v2, 7, s44
    s_lshl_b32 s0, s53, 3
    s_add_u32 s0, s0, s54
    s_lshl_b32 s0, s0, 7
    s_add_u32 s0, s0, 10878976
    s_cmp_eq_u32 s3, 0
    s_cselect_b32 s0, s0, 1073741824
    v_min_u32 v2, 21, v1
    v_lshrrev_b32 v3, 1, v2
    v_lshl_add_u32 v3, v3, 2, s3
    v_min_u32 v3, 41, v3
    v_mul_u32_u24 v3, 10, v3
    v_and_b32 v2, 1, v2
    s_mul_i32 s44, s54, 5
    s_lshr_b32 s44, s44, 2
    v_add3_u32 v2, v2, v3, s44
    v_lshlrev_b32 v2, 7, v2
    v_add_u32 v22, 10747904, v2
    v_add_u32 v2, 0, v1
    v_mul_u32_u24 v3, 205, v2
    v_lshrrev_b32 v3, 11, v3
    v_mul_u32_u24 v4, 1120, v3
    v_lshl_add_u32 v4, v2, 4, v4
    v_mov_b32 v120, v4
    v_add_u32 v2, 64, v1
    v_mul_u32_u24 v3, 205, v2
    v_lshrrev_b32 v3, 11, v3
    v_mul_u32_u24 v4, 1120, v3
    v_lshl_add_u32 v4, v2, 4, v4
    v_subrev_u32 v121, 1024, v4
    v_add_u32 v2, 128, v1
    v_mul_u32_u24 v3, 205, v2
    v_lshrrev_b32 v3, 11, v3
    v_mul_u32_u24 v4, 1120, v3
    v_lshl_add_u32 v4, v2, 4, v4
    v_subrev_u32 v122, 2048, v4
    v_add_u32 v2, 192, v1
    v_mul_u32_u24 v3, 205, v2
    v_lshrrev_b32 v3, 11, v3
    v_mul_u32_u24 v4, 1120, v3
    v_lshl_add_u32 v4, v2, 4, v4
    v_subrev_u32 v123, 3072, v4
    v_add_u32 v2, 256, v1
    v_mul_u32_u24 v3, 205, v2
    v_lshrrev_b32 v3, 11, v3
    v_mul_u32_u24 v4, 1120, v3
    v_lshl_add_u32 v4, v2, 4, v4
    v_mov_b32 v124, v4
    v_lshrrev_b32 v2, 5, v1
    v_bfe_u32 v3, v1, 4, 1
    v_bfe_u32 v4, v1, 2, 2
    v_lshlrev_b32 v2, 4, v2
    v_lshl_add_u32 v2, v3, 2, v2
    v_add_u32 v2, v2, v4
    v_mul_u32_u24 v2, 160, v2
    v_and_b32 v3, 3, v1
    v_lshl_add_u32 v2, v3, 3, v2
    v_add_u32 v125, s4, v2
    v_add_u32 v126, 61440, v125
    v_add_u32 v127, 122880, v125
    v_lshlrev_b32 v23, 24, v1
    v_mov_b32 v9, 0
    buffer_load_dwordx2 v[4:5], v9, s[32:35], 0 offen sc1
    s_waitcnt vmcnt(17)
    ds_read_b64_tr_b16 v[24:25], v212 offset:0
    ds_read_b64_tr_b16 v[26:27], v212 offset:1024
    ds_read_b64_tr_b16 v[28:29], v213 offset:0
    ds_read_b64_tr_b16 v[30:31], v213 offset:1024
    ds_read_b64_tr_b16 v[32:33], v214 offset:0
    ds_read_b64_tr_b16 v[34:35], v214 offset:1024
    ds_read_b64_tr_b16 v[36:37], v215 offset:0
    ds_read_b64_tr_b16 v[38:39], v215 offset:1024
    s_add_u32 s44, s42, 0
    s_lshl_b32 s45, s44, 12
    s_add_u32 s45, s45, 7340032
    s_cmp_ge_u32 s44, 420
    s_cselect_b32 s45, 1073741824, s45
    s_waitcnt lgkmcnt(6)
    buffer_store_dwordx4 v[24:27], v10, s[24:27], s45 offen offset:0 sc1
    s_waitcnt lgkmcnt(4)
    buffer_store_dwordx4 v[28:31], v10, s[24:27], s45 offen offset:1024 sc1
    s_waitcnt lgkmcnt(2)
    buffer_store_dwordx4 v[32:35], v10, s[24:27], s45 offen offset:2048 sc1
    s_waitcnt lgkmcnt(0)
    buffer_store_dwordx4 v[36:39], v10, s[24:27], s45 offen offset:3072 sc1
    s_waitcnt vmcnt(4)
    s_mov_b32 s57, 0
L_spin_n2:
    v_readfirstlane_b32 s58, v4
    v_readfirstlane_b32 s59, v5
    s_add_u32 s57, s57, 1
    s_cmp_lg_u32 s59, 0
    s_cbranch_scc1 L_ok_n2
    s_cmp_ge_u32 s57, 20000
    s_cbranch_scc1 L_ok_n2
    s_sleep 4
    buffer_load_dwordx2 v[4:5], v9, s[32:35], 0 offen sc1
    s_waitcnt vmcnt(0)
    s_branch L_spin_n2
L_ok_n2:
    s_nop 1
    s_xor_b32 s44, s58, s12
    v_mov_b32 v4, s44
    v_mov_b32 v5, s59
    v_mov_b32 v2, s58
    v_mov_b32 v3, s59
    buffer_store_dwordx2 v[4:5], v23, s[24:27], s0 offen sc1
    ds_read_b64_tr_b16 v[40:41], v212 offset:4096
    ds_read_b64_tr_b16 v[42:43], v212 offset:5120
    ds_read_b64_tr_b16 v[44:45], v213 offset:4096
    ds_read_b64_tr_b16 v[46:47], v213 offset:5120
    ds_read_b64_tr_b16 v[48:49], v214 offset:4096
    ds_read_b64_tr_b16 v[50:51], v214 offset:5120
    ds_read_b64_tr_b16 v[52:53], v215 offset:4096
    ds_read_b64_tr_b16 v[54:55], v215 offset:5120
    s_add_u32 s44, s42, 128
    s_lshl_b32 s45, s44, 12
    s_add_u32 s45, s45, 7340032
    s_cmp_ge_u32 s44, 420
    s_cselect_b32 s45, 1073741824, s45
    s_waitcnt lgkmcnt(6)
    buffer_store_dwordx4 v[40:43], v10, s[24:27], s45 offen offset:0 sc1
    s_waitcnt lgkmcnt(4)
    buffer_store_dwordx4 v[44:47], v10, s[24:27], s45 offen offset:1024 sc1
    s_waitcnt lgkmcnt(2)
    buffer_store_dwordx4 v[48:51], v10, s[24:27], s45 offen offset:2048 sc1
    s_waitcnt lgkmcnt(0)
    buffer_store_dwordx4 v[52:55], v10, s[24:27], s45 offen offset:3072 sc1
    ds_read_b64_tr_b16 v[56:57], v212 offset:8192
    ds_read_b64_tr_b16 v[58:59], v212 offset:9216
    ds_read_b64_tr_b16 v[60:61], v213 offset:8192
    ds_read_b64_tr_b16 v[62:63], v213 offset:9216
    ds_read_b64_tr_b16 v[64:65], v214 offset:8192
    ds_read_b64_tr_b16 v[66:67], v214 offset:9216
    ds_read_b64_tr_b16 v[68:69], v215 offset:8192
    ds_read_b64_tr_b16 v[70:71], v215 offset:9216
    s_add_u32 s44, s42, 256
    s_lshl_b32 s45, s44, 12
    s_add_u32 s45, s45, 7340032
    s_cmp_ge_u32 s44, 420
    s_cselect_b32 s45, 1073741824, s45
    s_waitcnt lgkmcnt(6)
    buffer_store_dwordx4 v[56:59], v10, s[24:27], s45 offen offset:0 sc1
    s_waitcnt lgkmcnt(4)
    buffer_store_dwordx4 v[60:63], v10, s[24:27], s45 offen offset:1024 sc1
    s_waitcnt lgkmcnt(2)
    buffer_store_dwordx4 v[64:67], v10, s[24:27], s45 offen offset:2048 sc1
    s_waitcnt lgkmcnt(0)
    buffer_store_dwordx4 v[68:71], v10, s[24:27], s45 offen offset:3072 sc1
    ds_read_b64_tr_b16 v[72:73], v212 offset:12288
    ds_read_b64_tr_b16 v[74:75], v212 offset:13312
    ds_read_b64_tr_b16 v[76:77], v213 offset:12288
    ds_read_b64_tr_b16 v[78:79], v213 offset:13312
    ds_read_b64_tr_b16 v[80:81], v214 offset:12288
    ds_read_b64_tr_b16 v[82:83], v214 offset:13312
    ds_read_b64_tr_b16 v[84:85], v215 offset:12288
    ds_read_b64_tr_b16 v[86:87], v215 offset:13312
    s_add_u32 s44, s42, 384
    s_lshl_b32 s45, s44, 12
    s_add_u32 s45, s45, 7340032
    s_cmp_ge_u32 s44, 420
    s_cselect_b32 s45, 1073741824, s45
    s_waitcnt lgkmcnt(6)
    buffer_store_dwordx4 v[72:75], v10, s[24:27], s45 offen offset:0 sc1
    s_waitcnt lgkmcnt(4)
    buffer_store_dwordx4 v[76:79], v10, s[24:27], s45 offen offset:1024 sc1
    s_waitcnt lgkmcnt(2)
    buffer_store_dwordx4 v[80:83], v10, s[24:27], s45 offen offset:2048 sc1
    s_waitcnt lgkmcnt(0)
    buffer_store_dwordx4 v[84:87], v10, s[24:27], s45 offen offset:3072 sc1
    s_waitcnt vmcnt(13)
    s_add_u32 s44, s42, 0
    s_lshl_b32 s45, s44, 7
    s_add_u32 s45, s45, 10747904
    s_cmp_ge_u32 s44, 420
    s_cselect_b32 s45, 1073741824, s45
    buffer_store_dwordx2 v[2:3], v23, s[24:27], s45 offen sc1
    s_waitcnt vmcnt(9)
    s_add_u32 s44, s42, 128
    s_lshl_b32 s45, s44, 7
    s_add_u32 s45, s45, 10747904
    s_cmp_ge_u32 s44, 420
    s_cselect_b32 s45, 1073741824, s45
    buffer_store_dwordx2 v[2:3], v23, s[24:27], s45 offen sc1
    s_waitcnt vmcnt(6)
    s_add_u32 s44, s42, 256
    s_lshl_b32 s45, s44, 7
    s_add_u32 s45, s45, 10747904
    s_cmp_ge_u32 s44, 420
    s_cselect_b32 s45, 1073741824, s45
    buffer_store_dwordx2 v[2:3], v23, s[24:27], s45 offen sc1
    s_waitcnt vmcnt(3)
    s_add_u32 s44, s42, 384
    s_lshl_b32 s45, s44, 7
    s_add_u32 s45, s45, 10747904
    s_cmp_ge_u32 s44, 420
    s_cselect_b32 s45, 1073741824, s45
    buffer_store_dwordx2 v[2:3], v23, s[24:27], s45 offen sc1
    s_barrier
    s_add_u32 s36, s36, 1
    s_cmp_eq_u32 s36, 3
    s_cselect_b32 s36, 0, s36
    s_mul_i32 s55, s36, 163840
    s_add_u32 s55, s55, s38
    s_add_u32 m0, s4, 0
    s_nop 0
    buffer_load_dwordx4 v120, s[8:11], s55 offen offset:0 lds
    buffer_load_dwordx4 v121, s[8:11], s55 offen offset:1024 lds
    buffer_load_dwordx4 v122, s[8:11], s55 offen offset:2048 lds
    buffer_load_dwordx4 v123, s[8:11], s55 offen offset:3072 lds
    s_add_u32 m0, s4, 4096
    s_nop 0
    buffer_load_dwordx4 v124, s[8:11], s55 offen offset:0 lds
    s_add_u32 s36, s36, 1
    s_cmp_eq_u32 s36, 3
    s_cselect_b32 s36, 0, s36
    s_mul_i32 s55, s36, 163840
    s_add_u32 s55, s55, s38
    s_add_u32 m0, s4, 20480
    s_nop 0
    buffer_load_dwordx4 v120, s[8:11], s55 offen offset:0 lds
    buffer_load_dwordx4 v121, s[8:11], s55 offen offset:1024 lds
    buffer_load_dwordx4 v122, s[8:11], s55 offen offset:2048 lds
    buffer_load_dwordx4 v123, s[8:11], s55 offen offset:3072 lds
    s_add_u32 m0, s4, 24576
    s_nop 0
    buffer_load_dwordx4 v124, s[8:11], s55 offen offset:0 lds
    s_add_u32 s36, s36, 1
    s_cmp_eq_u32 s36, 3
    s_cselect_b32 s36, 0, s36
    s_mul_i32 s55, s36, 163840
    s_add_u32 s55, s55, s38
    s_add_u32 m0, s4, 40960
    s_nop 0
    buffer_load_dwordx4 v120, s[8:11], s55 offen offset:0 lds
    buffer_load_dwordx4 v121, s[8:11], s55 offen offset:1024 lds
    buffer_load_dwordx4 v122, s[8:11], s55 offen offset:2048 lds
    buffer_load_dwordx4 v123, s[8:11], s55 offen offset:3072 lds
    s_add_u32 m0, s4, 45056
    s_nop 0
    buffer_load_dwordx4 v124, s[8:11], s55 offen offset:0 lds
    buffer_load_dwordx2 v[6:7], v22, s[24:27], 0 offen sc1
    s_waitcnt vmcnt(0)
    s_mov_b32 s57, 0
L_spin_w2b:
    v_cmp_eq_u64 vcc, s[58:59], v[6:7]
    s_add_u32 s57, s57, 1
    s_cmp_eq_u64 vcc, exec
    s_cbranch_scc1 L_ok_w2b
    s_cmp_ge_u32 s57, 20000
    s_cbranch_scc1 L_ok_w2b
    s_sleep 8
    buffer_load_dwordx2 v[6:7], v22, s[24:27], 0 offen sc1
    s_waitcnt vmcnt(0)
    s_branch L_spin_w2b
L_ok_w2b:
    s_add_u32 s6, s6, 1
    s_cmp_eq_u32 s6, 11
    s_cselect_b32 s6, 0, s6
    s_mul_i32 s55, s6, 163840
    s_add_u32 s55, s55, s5
    s_cmp_eq_u32 s6, s99
    s_cselect_b32 s55, 1073741824, s55
    buffer_load_dwordx4 a[60:63], v10, s[24:27], s55 offen offset:0 sc1
    buffer_load_dwordx4 a[64:67], v10, s[24:27], s55 offen offset:1024 sc1
    buffer_load_dwordx4 a[68:71], v10, s[24:27], s55 offen offset:2048 sc1
    buffer_load_dwordx4 a[72:75], v10, s[24:27], s55 offen offset:3072 sc1
    buffer_load_dwordx4 a[76:79], v11, s[24:27], s55 offen sc1
    s_add_u32 s6, s6, 1
    s_cmp_eq_u32 s6, 11
    s_cselect_b32 s6, 0, s6
    s_mul_i32 s55, s6, 163840
    s_add_u32 s55, s55, s5
    s_cmp_eq_u32 s6, s99
    s_cselect_b32 s55, 1073741824, s55
    buffer_load_dwordx4 a[80:83], v10, s[24:27], s55 offen offset:0 sc1
    buffer_load_dwordx4 a[84:87], v10, s[24:27], s55 offen offset:1024 sc1
    buffer_load_dwordx4 a[88:91], v10, s[24:27], s55 offen offset:2048 sc1
    buffer_load_dwordx4 a[92:95], v10, s[24:27], s55 offen offset:3072 sc1
    buffer_load_dwordx4 a[96:99], v11, s[24:27], s55 offen sc1
    s_add_u32 s6, s6, 1
    s_cmp_eq_u32 s6, 11
    s_cselect_b32 s6, 0, s6
    s_mul_i32 s55, s6, 163840
    s_add_u32 s55, s55, s5
    s_cmp_eq_u32 s6, s99
    s_cselect_b32 s55, 1073741824, s55
    buffer_load_dwordx4 a[100:103], v10, s[24:27], s55 offen offset:0 sc1
    buffer_load_dwordx4 a[104:107], v10, s[24:27], s55 offen offset:1024 sc1
    buffer_load_dwordx4 a[108:111], v10, s[24:27], s55 offen offset:2048 sc1
    buffer_load_dwordx4 a[112:115], v10, s[24:27], s55 offen offset:3072 sc1
    buffer_load_dwordx4 a[116:119], v11, s[24:27], s55 offen sc1
    s_add_u32 s6, s6, 1
    s_cmp_eq_u32 s6, 11
    s_cselect_b32 s6, 0, s6
    s_mul_i32 s55, s6, 163840
    s_add_u32 s55, s55, s5
    s_cmp_eq_u32 s6, s99
    s_cselect_b32 s55, 1073741824, s55
    buffer_load_dwordx4 a[120:123], v10, s[24:27], s55 offen offset:0 sc1
    buffer_load_dwordx4 a[124:127], v10, s[24:27], s55 offen offset:1024 sc1
    buffer_load_dwordx4 a[128:131], v10, s[24:27], s55 offen offset:2048 sc1
    buffer_load_dwordx4 a[132:135], v10, s[24:27], s55 offen offset:3072 sc1
    buffer_load_dwordx4 a[136:139], v11, s[24:27], s55 offen sc1
    s_add_u32 s6, s6, 1
    s_cmp_eq_u32 s6, 11
    s_cselect_b32 s6, 0, s6
    s_mul_i32 s55, s6, 163840
    s_add_u32 s55, s55, s5
    s_cmp_eq_u32 s6, s99
    s_cselect_b32 s55, 1073741824, s55
    buffer_load_dwordx4 a[140:143], v10, s[24:27], s55 offen offset:0 sc1
    buffer_load_dwordx4 a[144:147], v10, s[24:27], s55 offen offset:1024 sc1
    buffer_load_dwordx4 a[148:151], v10, s[24:27], s55 offen offset:2048 sc1
    buffer_load_dwordx4 a[152:155], v10, s[24:27], s55 offen offset:3072 sc1
    buffer_load_dwordx4 a[156:159], v11, s[24:27], s55 offen sc1
    s_add_u32 s6, s6, 1
    s_cmp_eq_u32 s6, 11
    s_cselect_b32 s6, 0, s6
    s_mul_i32 s55, s6, 163840
    s_add_u32 s55, s55, s5
    s_cmp_eq_u32 s6, s99
    s_cselect_b32 s55, 1073741824, s55
    buffer_load_dwordx4 a[160:163], v10, s[24:27], s55 offen offset:0 sc1
    buffer_load_dwordx4 a[164:167], v10, s[24:27], s55 offen offset:1024 sc1
    buffer_load_dwordx4 a[168:171], v10, s[24:27], s55 offen offset:2048 sc1
    buffer_load_dwordx4 a[172:175], v10, s[24:27], s55 offen offset:3072 sc1
    buffer_load_dwordx4 a[176:179], v11, s[24:27], s55 offen sc1
    s_add_u32 s6, s6, 1
    s_cmp_eq_u32 s6, 11
    s_cselect_b32 s6, 0, s6
    s_mul_i32 s55, s6, 163840
    s_add_u32 s55, s55, s5
    s_cmp_eq_u32 s6, s99
    s_cselect_b32 s55, 1073741824, s55
    buffer_load_dwordx4 a[180:183], v10, s[24:27], s55 offen offset:0 sc1
    buffer_load_dwordx4 a[184:187], v10, s[24:27], s55 offen offset:1024 sc1
    buffer_load_dwordx4 a[188:191], v10, s[24:27], s55 offen offset:2048 sc1
    buffer_load_dwordx4 a[192:195], v10, s[24:27], s55 offen offset:3072 sc1
    buffer_load_dwordx4 a[196:199], v11, s[24:27], s55 offen sc1
    s_add_u32 s6, s6, 1
    s_cmp_eq_u32 s6, 11
    s_cselect_b32 s6, 0, s6
    s_mul_i32 s55, s6, 163840
    s_add_u32 s55, s55, s5
    s_cmp_eq_u32 s6, s99
    s_cselect_b32 s55, 1073741824, s55
    buffer_load_dwordx4 a[200:203], v10, s[24:27], s55 offen offset:0 sc1
    buffer_load_dwordx4 a[204:207], v10, s[24:27], s55 offen offset:1024 sc1
    buffer_load_dwordx4 a[208:211], v10, s[24:27], s55 offen offset:2048 sc1
    buffer_load_dwordx4 a[212:215], v10, s[24:27], s55 offen offset:3072 sc1
    buffer_load_dwordx4 a[216:219], v11, s[24:27], s55 offen sc1
    s_add_u32 s6, s6, 1
    s_cmp_eq_u32 s6, 11
    s_cselect_b32 s6, 0, s6
    s_mul_i32 s55, s6, 163840
    s_add_u32 s55, s55, s5
    s_cmp_eq_u32 s6, s99
    s_cselect_b32 s55, 1073741824, s55
    buffer_load_dwordx4 a[220:223], v10, s[24:27], s55 offen offset:0 sc1
    buffer_load_dwordx4 a[224:227], v10, s[24:27], s55 offen offset:1024 sc1
    buffer_load_dwordx4 a[228:231], v10, s[24:27], s55 offen offset:2048 sc1
    buffer_load_dwordx4 a[232:235], v10, s[24:27], s55 offen offset:3072 sc1
    buffer_load_dwordx4 a[236:239], v11, s[24:27], s55 offen sc1
    s_add_u32 s6, s6, 1
    s_cmp_eq_u32 s6, 11
    s_cselect_b32 s6, 0, s6
    s_mul_i32 s55, s6, 163840
    s_add_u32 s55, s55, s5
    s_cmp_eq_u32 s6, s99
    s_cselect_b32 s55, 1073741824, s55
    buffer_load_dwordx4 v[136:139], v10, s[24:27], s55 offen offset:0 sc1
    buffer_load_dwordx4 v[140:143], v10, s[24:27], s55 offen offset:1024 sc1
    buffer_load_dwordx4 v[144:147], v10, s[24:27], s55 offen offset:2048 sc1
    buffer_load_dwordx4 v[148:151], v10, s[24:27], s55 offen offset:3072 sc1
    buffer_load_dwordx4 v[152:155], v11, s[24:27], s55 offen sc1
    s_add_u32 s6, s6, 1
    s_cmp_eq_u32 s6, 11
    s_cselect_b32 s6, 0, s6
    s_mul_i32 s55, s6, 163840
    s_add_u32 s55, s55, s5
    s_cmp_eq_u32 s6, s99
    s_cselect_b32 s55, 1073741824, s55
    buffer_load_dwordx4 v[156:159], v10, s[24:27], s55 offen offset:0 sc1
    buffer_load_dwordx4 v[160:163], v10, s[24:27], s55 offen offset:1024 sc1
    buffer_load_dwordx4 v[164:167], v10, s[24:27], s55 offen offset:2048 sc1
    buffer_load_dwordx4 v[168:171], v10, s[24:27], s55 offen offset:3072 sc1
    buffer_load_dwordx4 v[172:175], v11, s[24:27], s55 offen sc1
    ds_read_b64_tr_b16 a[0:1], v125 offset:0
    ds_read_b64_tr_b16 a[2:3], v125 offset:1280
    ds_read_b64_tr_b16 a[4:5], v125 offset:32
    ds_read_b64_tr_b16 a[6:7], v125 offset:1312
    ds_read_b64_tr_b16 a[8:9], v125 offset:64
    ds_read_b64_tr_b16 a[10:11], v125 offset:1344
    ds_read_b64_tr_b16 a[12:13], v125 offset:96
    ds_read_b64_tr_b16 a[14:15], v125 offset:1376
    ds_read_b64_tr_b16 a[16:17], v125 offset:128
    ds_read_b64_tr_b16 a[18:19], v125 offset:1408
    ds_read_b64_tr_b16 a[20:21], v125 offset:20480
    ds_read_b64_tr_b16 a[22:23], v125 offset:21760
    s_waitcnt vmcnt(0) lgkmcnt(0)
L_join:
    buffer_load_dwordx2 v[6:7], v21, s[24:27], 0 offen sc1
    ds_read_b64_tr_b16 a[24:25], v125 offset:20512
    ds_read_b64_tr_b16 a[26:27], v125 offset:21792
    ds_read_b64_tr_b16 a[28:29], v125 offset:20544
    ds_read_b64_tr_b16 a[30:31], v125 offset:21824
    ds_read_b64_tr_b16 a[32:33], v125 offset:20576
    ds_read_b64_tr_b16 a[34:35], v125 offset:21856
    ds_read_b64_tr_b16 a[36:37], v125 offset:20608
    ds_read_b64_tr_b16 a[38:39], v125 offset:21888
    ds_read_b64_tr_b16 a[40:41], v125 offset:40960
    ds_read_b64_tr_b16 a[42:43], v125 offset:42240
    ds_read_b64_tr_b16 a[44:45], v125 offset:40992
    ds_read_b64_tr_b16 a[46:47], v125 offset:42272
    ds_read_b64_tr_b16 a[48:49], v125 offset:41024
    ds_read_b64_tr_b16 a[50:51], v125 offset:42304
    ds_read_b64_tr_b16 a[52:53], v125 offset:41056
    ds_read_b64_tr_b16 a[54:55], v125 offset:42336
    ds_read_b64_tr_b16 a[56:57], v125 offset:41088
    ds_read_b64_tr_b16 a[58:59], v125 offset:42368
    s_waitcnt vmcnt(0)
    s_mov_b32 s57, 0
L_spin_h:
    v_cmp_eq_u64 vcc, s[58:59], v[6:7]
    s_add_u32 s57, s57, 1
    s_cmp_eq_u64 vcc, exec
    s_cbranch_scc1 L_ok_h
    s_cmp_ge_u32 s57, 20000
    s_cbranch_scc1 L_ok_h
    s_sleep 4
    buffer_load_dwordx2 v[6:7], v21, s[24:27], 0 offen sc1
    s_waitcnt vmcnt(0)
    s_branch L_spin_h
L_ok_h:
    s_add_u32 s37, s37, 1
    s_cmp_eq_u32 s37, 3
    s_cselect_b32 s37, 0, s37
    s_mul_i32 s48, s37, 16384
    s_add_u32 s48, s48, s39
    buffer_load_dwordx4 v[24:27], v12, s[24:27], s48 offen sc1
    buffer_load_dwordx4 v[28:31], v13, s[24:27], s48 offen sc1
    buffer_load_dwordx4 v[32:35], v14, s[24:27], s48 offen sc1
    buffer_load_dwordx4 v[36:39], v15, s[24:27], s48 offen sc1
    s_add_u32 s37, s37, 1
    s_cmp_eq_u32 s37, 3
    s_cselect_b32 s37, 0, s37
    s_mul_i32 s49, s37, 16384
    s_add_u32 s49, s49, s39
    buffer_load_dwordx4 v[40:43], v12, s[24:27], s49 offen sc1
    buffer_load_dwordx4 v[44:47], v13, s[24:27], s49 offen sc1
    buffer_load_dwordx4 v[48:51], v14, s[24:27], s49 offen sc1
    buffer_load_dwordx4 v[52:55], v15, s[24:27], s49 offen sc1
    s_add_u32 s37, s37, 1
    s_cmp_eq_u32 s37, 3
    s_cselect_b32 s37, 0, s37
    s_mul_i32 s50, s37, 16384
    s_add_u32 s50, s50, s39
    buffer_load_dwordx4 v[56:59], v12, s[24:27], s50 offen sc1
    buffer_load_dwordx4 v[60:63], v13, s[24:27], s50 offen sc1
    buffer_load_dwordx4 v[64:67], v14, s[24:27], s50 offen sc1
    buffer_load_dwordx4 v[68:71], v15, s[24:27], s50 offen sc1
    s_waitcnt vmcnt(11)
    s_waitcnt lgkmcnt(15)
    v_mfma_f32_16x16x32_bf16 v[176:179], a[0:3], v[24:27], 0
    v_mfma_f32_16x16x32_bf16 v[180:183], a[4:7], v[24:27], 0
    s_add_u32 s7, s7, 1
    s_cmp_eq_u32 s7, 11
    s_cselect_b32 s7, 0, s7
    s_mul_i32 s96, s7, 16384
    s_add_u32 s96, s96, s39
    s_add_u32 s96, s96, 49152
    s_cmp_eq_u32 s7, s99
    s_cselect_b32 s96, 1073741824, s96
    buffer_load_dwordx4 v[72:75], v12, s[24:27], s96 offen sc1
    v_mfma_f32_16x16x32_bf16 v[184:187], a[8:11], v[24:27], 0
    v_mfma_f32_16x16x32_bf16 v[188:191], a[12:15], v[24:27], 0
    v_mfma_f32_16x16x32_bf16 v[192:195], a[16:19], v[24:27], 0
    s_waitcnt lgkmcnt(0)
    s_barrier
    s_waitcnt vmcnt(11)
    v_mfma_f32_16x16x32_bf16 v[196:199], a[0:3], v[28:31], 0
    v_mfma_f32_16x16x32_bf16 v[200:203], a[4:7], v[28:31], 0
    buffer_load_dwordx4 v[76:79], v13, s[24:27], s96 offen sc1
    v_mfma_f32_16x16x32_bf16 v[204:207], a[8:11], v[28:31], 0
    v_mfma_f32_16x16x32_bf16 v[208:211], a[12:15], v[28:31], 0
    v_mfma_f32_16x16x32_bf16 v[212:215], a[16:19], v[28:31], 0
    s_waitcnt vmcnt(11)
    v_mfma_f32_16x16x32_bf16 v[216:219], a[0:3], v[32:35], 0
    v_mfma_f32_16x16x32_bf16 v[220:223], a[4:7], v[32:35], 0
    buffer_load_dwordx4 v[80:83], v14, s[24:27], s96 offen sc1
    v_mfma_f32_16x16x32_bf16 v[224:227], a[8:11], v[32:35], 0
    v_mfma_f32_16x16x32_bf16 v[228:231], a[12:15], v[32:35], 0
    v_mfma_f32_16x16x32_bf16 v[232:235], a[16:19], v[32:35], 0
    s_waitcnt vmcnt(11)
    v_mfma_f32_16x16x32_bf16 v[236:239], a[0:3], v[36:39], 0
    v_mfma_f32_16x16x32_bf16 v[240:243], a[4:7], v[36:39], 0
    buffer_load_dwordx4 v[84:87], v15, s[24:27], s96 offen sc1
    v_mfma_f32_16x16x32_bf16 v[244:247], a[8:11], v[36:39], 0
    v_mfma_f32_16x16x32_bf16 v[248:251], a[12:15], v[36:39], 0
    v_mfma_f32_16x16x32_bf16 v[252:255], a[16:19], v[36:39], 0
    s_waitcnt vmcnt(11)
    v_mfma_f32_16x16x32_bf16 v[176:179], a[20:23], v[40:43], v[176:179]
    v_mfma_f32_16x16x32_bf16 v[180:183], a[24:27], v[40:43], v[180:183]
    s_add_u32 s7, s7, 1
    s_cmp_eq_u32 s7, 11
    s_cselect_b32 s7, 0, s7
    s_mul_i32 s97, s7, 16384
    s_add_u32 s97, s97, s39
    s_add_u32 s97, s97, 49152
    s_cmp_eq_u32 s7, s99
    s_cselect_b32 s97, 1073741824, s97
    buffer_load_dwordx4 v[88:91], v12, s[24:27], s97 offen sc1
    v_mfma_f32_16x16x32_bf16 v[184:187], a[28:31], v[40:43], v[184:187]
    v_mfma_f32_16x16x32_bf16 v[188:191], a[32:35], v[40:43], v[188:191]
    v_mfma_f32_16x16x32_bf16 v[192:195], a[36:39], v[40:43], v[192:195]
    s_waitcnt vmcnt(11)
    v_mfma_f32_16x16x32_bf16 v[196:199], a[20:23], v[44:47], v[196:199]
    v_mfma_f32_16x16x32_bf16 v[200:203], a[24:27], v[44:47], v[200:203]
    buffer_load_dwordx4 v[92:95], v13, s[24:27], s97 offen sc1
    v_mfma_f32_16x16x32_bf16 v[204:207], a[28:31], v[44:47], v[204:207]
    v_mfma_f32_16x16x32_bf16 v[208:211], a[32:35], v[44:47], v[208:211]
    v_mfma_f32_16x16x32_bf16 v[212:215], a[36:39], v[44:47], v[212:215]
    s_waitcnt vmcnt(11)
    v_mfma_f32_16x16x32_bf16 v[216:219], a[20:23], v[48:51], v[216:219]
    v_mfma_f32_16x16x32_bf16 v[220:223], a[24:27], v[48:51], v[220:223]
    buffer_load_dwordx4 v[96:99], v14, s[24:27], s97 offen sc1
    v_mfma_f32_16x16x32_bf16 v[224:227], a[28:31], v[48:51], v[224:227]
    v_mfma_f32_16x16x32_bf16 v[228:231], a[32:35], v[48:51], v[228:231]
    v_mfma_f32_16x16x32_bf16 v[232:235], a[36:39], v[48:51], v[232:235]
    s_waitcnt vmcnt(11)
    v_mfma_f32_16x16x32_bf16 v[236:239], a[20:23], v[52:55], v[236:239]
    v_mfma_f32_16x16x32_bf16 v[240:243], a[24:27], v[52:55], v[240:243]
    buffer_load_dwordx4 v[100:103], v15, s[24:27], s97 offen sc1
    v_mfma_f32_16x16x32_bf16 v[244:247], a[28:31], v[52:55], v[244:247]
    v_mfma_f32_16x16x32_bf16 v[248:251], a[32:35], v[52:55], v[248:251]
    v_mfma_f32_16x16x32_bf16 v[252:255], a[36:39], v[52:55], v[252:255]
    s_waitcnt vmcnt(11)
    v_mfma_f32_16x16x32_bf16 v[176:179], a[40:43], v[56:59], v[176:179]
    v_mfma_f32_16x16x32_bf16 v[180:183], a[44:47], v[56:59], v[180:183]
    s_add_u32 s7, s7, 1
    s_cmp_eq_u32 s7, 11
    s_cselect_b32 s7, 0, s7
    s_mul_i32 s98, s7, 16384
    s_add_u32 s98, s98, s39
    s_add_u32 s98, s98, 49152
    s_cmp_eq_u32 s7, s99
    s_cselect_b32 s98, 1073741824, s98
    buffer_load_dwordx4 v[104:107], v12, s[24:27], s98 offen sc1
    v_mfma_f32_16x16x32_bf16 v[184:187], a[48:51], v[56:59], v[184:187]
    v_mfma_f32_16x16x32_bf16 v[188:191], a[52:55], v[56:59], v[188:191]
    v_mfma_f32_16x16x32_bf16 v[192:195], a[56:59], v[56:59], v[192:195]
    s_waitcnt vmcnt(11)
    v_mfma_f32_16x16x32_bf16 v[196:199], a[40:43], v[60:63], v[196:199]
    v_mfma_f32_16x16x32_bf16 v[200:203], a[44:47], v[60:63], v[200:203]
    buffer_load_dwordx4 v[108:111], v13, s[24:27], s98 offen sc1
    v_mfma_f32_16x16x32_bf16 v[204:207], a[48:51], v[60:63], v[204:207]
    v_mfma_f32_16x16x32_bf16 v[208:211], a[52:55], v[60:63], v[208:211]
    v_mfma_f32_16x16x32_bf16 v[212:215], a[56:59], v[60:63], v[212:215]
    s_waitcnt vmcnt(11)
    v_mfma_f32_16x16x32_bf16 v[216:219], a[40:43], v[64:67], v[216:219]
    v_mfma_f32_16x16x32_bf16 v[220:223], a[44:47], v[64:67], v[220:223]
    buffer_load_dwordx4 v[112:115], v14, s[24:27], s98 offen sc1
    v_mfma_f32_16x16x32_bf16 v[224:227], a[48:51], v[64:67], v[224:227]
    v_mfma_f32_16x16x32_bf16 v[228:231], a[52:55], v[64:67], v[228:231]
    v_mfma_f32_16x16x32_bf16 v[232:235], a[56:59], v[64:67], v[232:235]
    s_waitcnt vmcnt(11)
    v_mfma_f32_16x16x32_bf16 v[236:239], a[40:43], v[68:71], v[236:239]
    v_mfma_f32_16x16x32_bf16 v[240:243], a[44:47], v[68:71], v[240:243]
    buffer_load_dwordx4 v[116:119], v15, s[24:27], s98 offen sc1
    v_mfma_f32_16x16x32_bf16 v[244:247], a[48:51], v[68:71], v[244:247]
    v_mfma_f32_16x16x32_bf16 v[248:251], a[52:55], v[68:71], v[248:251]
    v_mfma_f32_16x16x32_bf16 v[252:255], a[56:59], v[68:71], v[252:255]
    s_waitcnt vmcnt(11)
    v_mfma_f32_16x16x32_bf16 v[176:179], a[60:63], v[72:75], v[176:179]
    v_mfma_f32_16x16x32_bf16 v[180:183], a[64:67], v[72:75], v[180:183]
    s_add_u32 s7, s7, 1
    s_cmp_eq_u32 s7, 11
    s_cselect_b32 s7, 0, s7
    s_mul_i32 s48, s7, 16384
    s_add_u32 s48, s48, s39
    s_add_u32 s48, s48, 49152
    s_cmp_eq_u32 s7, s99
    s_cselect_b32 s48, 1073741824, s48
    buffer_load_dwordx4 v[24:27], v12, s[24:27], s48 offen sc1
    v_mfma_f32_16x16x32_bf16 v[184:187], a[68:71], v[72:75], v[184:187]
    v_mfma_f32_16x16x32_bf16 v[188:191], a[72:75], v[72:75], v[188:191]
    v_mfma_f32_16x16x32_bf16 v[192:195], a[76:79], v[72:75], v[192:195]
    s_waitcnt vmcnt(11)
    v_mfma_f32_16x16x32_bf16 v[196:199], a[60:63], v[76:79], v[196:199]
    v_mfma_f32_16x16x32_bf16 v[200:203], a[64:67], v[76:79], v[200:203]
    buffer_load_dwordx4 v[28:31], v13, s[24:27], s48 offen sc1
    v_mfma_f32_16x16x32_bf16 v[204:207], a[68:71], v[76:79], v[204:207]
    v_mfma_f32_16x16x32_bf16 v[208:211], a[72:75], v[76:79], v[208:211]
    v_mfma_f32_16x16x32_bf16 v[212:215], a[76:79], v[76:79], v[212:215]
    s_waitcnt vmcnt(11)
    v_mfma_f32_16x16x32_bf16 v[216:219], a[60:63], v[80:83], v[216:219]
    v_mfma_f32_16x16x32_bf16 v[220:223], a[64:67], v[80:83], v[220:223]
    buffer_load_dwordx4 v[32:35], v14, s[24:27], s48 offen sc1
    v_mfma_f32_16x16x32_bf16 v[224:227], a[68:71], v[80:83], v[224:227]
    v_mfma_f32_16x16x32_bf16 v[228:231], a[72:75], v[80:83], v[228:231]
    v_mfma_f32_16x16x32_bf16 v[232:235], a[76:79], v[80:83], v[232:235]
    s_waitcnt vmcnt(11)
    v_mfma_f32_16x16x32_bf16 v[236:239], a[60:63], v[84:87], v[236:239]
    v_mfma_f32_16x16x32_bf16 v[240:243], a[64:67], v[84:87], v[240:243]
    buffer_load_dwordx4 v[36:39], v15, s[24:27], s48 offen sc1
    v_mfma_f32_16x16x32_bf16 v[244:247], a[68:71], v[84:87], v[244:247]
    v_mfma_f32_16x16x32_bf16 v[248:251], a[72:75], v[84:87], v[248:251]
    v_mfma_f32_16x16x32_bf16 v[252:255], a[76:79], v[84:87], v[252:255]
    s_waitcnt vmcnt(11)
    v_mfma_f32_16x16x32_bf16 v[176:179], a[80:83], v[88:91], v[176:179]
    v_mfma_f32_16x16x32_bf16 v[180:183], a[84:87], v[88:91], v[180:183]
    s_add_u32 s7, s7, 1
    s_cmp_eq_u32 s7, 11
    s_cselect_b32 s7, 0, s7
    s_mul_i32 s49, s7, 16384
    s_add_u32 s49, s49, s39
    s_add_u32 s49, s49, 49152
    s_cmp_eq_u32 s7, s99
    s_cselect_b32 s49, 1073741824, s49
    buffer_load_dwordx4 v[40:43], v12, s[24:27], s49 offen sc1
    v_mfma_f32_16x16x32_bf16 v[184:187], a[88:91], v[88:91], v[184:187]
    v_mfma_f32_16x16x32_bf16 v[188:191], a[92:95], v[88:91], v[188:191]
    v_mfma_f32_16x16x32_bf16 v[192:195], a[96:99], v[88:91], v[192:195]
    s_waitcnt vmcnt(11)
    v_mfma_f32_16x16x32_bf16 v[196:199], a[80:83], v[92:95], v[196:199]
    v_mfma_f32_16x16x32_bf16 v[200:203], a[84:87], v[92:95], v[200:203]
    buffer_load_dwordx4 v[44:47], v13, s[24:27], s49 offen sc1
    v_mfma_f32_16x16x32_bf16 v[204:207], a[88:91], v[92:95], v[204:207]
    v_mfma_f32_16x16x32_bf16 v[208:211], a[92:95], v[92:95], v[208:211]
    v_mfma_f32_16x16x32_bf16 v[212:215], a[96:99], v[92:95], v[212:215]
    s_waitcnt vmcnt(11)
    v_mfma_f32_16x16x32_bf16 v[216:219], a[80:83], v[96:99], v[216:219]
    v_mfma_f32_16x16x32_bf16 v[220:223], a[84:87], v[96:99], v[220:223]
    buffer_load_dwordx4 v[48:51], v14, s[24:27], s49 offen sc1
    v_mfma_f32_16x16x32_bf16 v[224:227], a[88:91], v[96:99], v[224:227]
    v_mfma_f32_16x16x32_bf16 v[228:231], a[92:95], v[96:99], v[228:231]
    v_mfma_f32_16x16x32_bf16 v[232:235], a[96:99], v[96:99], v[232:235]
    s_waitcnt vmcnt(11)
    v_mfma_f32_16x16x32_bf16 v[236:239], a[80:83], v[100:103], v[236:239]
    v_mfma_f32_16x16x32_bf16 v[240:243], a[84:87], v[100:103], v[240:243]
    buffer_load_dwordx4 v[52:55], v15, s[24:27], s49 offen sc1
    v_mfma_f32_16x16x32_bf16 v[244:247], a[88:91], v[100:103], v[244:247]
    v_mfma_f32_16x16x32_bf16 v[248:251], a[92:95], v[100:103], v[248:251]
    v_mfma_f32_16x16x32_bf16 v[252:255], a[96:99], v[100:103], v[252:255]
    s_waitcnt vmcnt(11)
    v_mfma_f32_16x16x32_bf16 v[176:179], a[100:103], v[104:107], v[176:179]
    v_mfma_f32_16x16x32_bf16 v[180:183], a[104:107], v[104:107], v[180:183]
    s_add_u32 s7, s7, 1
    s_cmp_eq_u32 s7, 11
    s_cselect_b32 s7, 0, s7
    s_mul_i32 s50, s7, 16384
    s_add_u32 s50, s50, s39
    s_add_u32 s50, s50, 49152
    s_cmp_eq_u32 s7, s99
    s_cselect_b32 s50, 1073741824, s50
    buffer_load_dwordx4 v[56:59], v12, s[24:27], s50 offen sc1
    v_mfma_f32_16x16x32_bf16 v[184:187], a[108:111], v[104:107], v[184:187]
    v_mfma_f32_16x16x32_bf16 v[188:191], a[112:115], v[104:107], v[188:191]
    v_mfma_f32_16x16x32_bf16 v[192:195], a[116:119], v[104:107], v[192:195]
    s_waitcnt vmcnt(11)
    v_mfma_f32_16x16x32_bf16 v[196:199], a[100:103], v[108:111], v[196:199]
    v_mfma_f32_16x16x32_bf16 v[200:203], a[104:107], v[108:111], v[200:203]
    buffer_load_dwordx4 v[60:63], v13, s[24:27], s50 offen sc1
    v_mfma_f32_16x16x32_bf16 v[204:207], a[108:111], v[108:111], v[204:207]
    v_mfma_f32_16x16x32_bf16 v[208:211], a[112:115], v[108:111], v[208:211]
    v_mfma_f32_16x16x32_bf16 v[212:215], a[116:119], v[108:111], v[212:215]
    s_waitcnt vmcnt(11)
    v_mfma_f32_16x16x32_bf16 v[216:219], a[100:103], v[112:115], v[216:219]
    v_mfma_f32_16x16x32_bf16 v[220:223], a[104:107], v[112:115], v[220:223]
    buffer_load_dwordx4 v[64:67], v14, s[24:27], s50 offen sc1
    v_mfma_f32_16x16x32_bf16 v[224:227], a[108:111], v[112:115], v[224:227]
    v_mfma_f32_16x16x32_bf16 v[228:231], a[112:115], v[112:115], v[228:231]
    v_mfma_f32_16x16x32_bf16 v[232:235], a[116:119], v[112:115], v[232:235]
    s_waitcnt vmcnt(11)
    v_mfma_f32_16x16x32_bf16 v[236:239], a[100:103], v[116:119], v[236:239]
    v_mfma_f32_16x16x32_bf16 v[240:243], a[104:107], v[116:119], v[240:243]
    buffer_load_dwordx4 v[68:71], v15, s[24:27], s50 offen sc1
    v_mfma_f32_16x16x32_bf16 v[244:247], a[108:111], v[116:119], v[244:247]
    v_mfma_f32_16x16x32_bf16 v[248:251], a[112:115], v[116:119], v[248:251]
    v_mfma_f32_16x16x32_bf16 v[252:255], a[116:119], v[116:119], v[252:255]
    s_waitcnt vmcnt(11)
    v_mfma_f32_16x16x32_bf16 v[176:179], a[120:123], v[24:27], v[176:179]
    v_mfma_f32_16x16x32_bf16 v[180:183], a[124:127], v[24:27], v[180:183]
    s_add_u32 s7, s7, 1
    s_cmp_eq_u32 s7, 11
    s_cselect_b32 s7, 0, s7
    s_mul_i32 s96, s7, 16384
    s_add_u32 s96, s96, s39
    s_add_u32 s96, s96, 49152
    s_cmp_eq_u32 s7, s99
    s_cselect_b32 s96, 1073741824, s96
    s_add_u32 s7, s7, 1
    s_cmp_eq_u32 s7, 11
    s_cselect_b32 s7, 0, s7
    s_mul_i32 s97, s7, 16384
    s_add_u32 s97, s97, s39
    s_add_u32 s97, s97, 49152
    s_cmp_eq_u32 s7, s99
    s_cselect_b32 s97, 1073741824, s97
    s_add_u32 s7, s7, 1
    s_cmp_eq_u32 s7, 11
    s_cselect_b32 s7, 0, s7
    s_mul_i32 s98, s7, 16384
    s_add_u32 s98, s98, s39
    s_add_u32 s98, s98, 49152
    s_cmp_eq_u32 s7, s99
    s_cselect_b32 s98, 1073741824, s98
    s_add_u32 s7, s7, 1
    s_cmp_eq_u32 s7, 11
    s_cselect_b32 s7, 0, s7
    s_mul_i32 s48, s7, 16384
    s_add_u32 s48, s48, s39
    s_add_u32 s48, s48, 49152
    s_cmp_eq_u32 s7, s99
    s_cselect_b32 s48, 1073741824, s48
    s_add_u32 s7, s7, 1
    s_cmp_eq_u32 s7, 11
    s_cselect_b32 s7, 0, s7
    s_mul_i32 s49, s7, 16384
    s_add_u32 s49, s49, s39
    s_add_u32 s49, s49, 49152
    s_cmp_eq_u32 s7, s99
    s_cselect_b32 s49, 1073741824, s49
    buffer_load_dwordx4 v[76:79], v13, s[24:27], s96 offen sc1
    v_mfma_f32_16x16x32_bf16 v[184:187], a[128:131], v[24:27], v[184:187]
    v_mfma_f32_16x16x32_bf16 v[188:191], a[132:135], v[24:27], v[188:191]
    v_mfma_f32_16x16x32_bf16 v[192:195], a[136:139], v[24:27], v[192:195]
    s_waitcnt vmcnt(11)
    v_mfma_f32_16x16x32_bf16 v[196:199], a[120:123], v[28:31], v[196:199]
    v_mfma_f32_16x16x32_bf16 v[200:203], a[124:127], v[28:31], v[200:203]
    buffer_load_dwordx4 v[92:95], v13, s[24:27], s97 offen sc1
    v_mfma_f32_16x16x32_bf16 v[204:207], a[128:131], v[28:31], v[204:207]
    v_mfma_f32_16x16x32_bf16 v[208:211], a[132:135], v[28:31], v[208:211]
    v_mfma_f32_16x16x32_bf16 v[212:215], a[136:139], v[28:31], v[212:215]
    s_waitcnt vmcnt(11)
    v_mfma_f32_16x16x32_bf16 v[216:219], a[120:123], v[32:35], v[216:219]
    v_mfma_f32_16x16x32_bf16 v[220:223], a[124:127], v[32:35], v[220:223]
    buffer_load_dwordx4 v[108:111], v13, s[24:27], s98 offen sc1
    v_mfma_f32_16x16x32_bf16 v[224:227], a[128:131], v[32:35], v[224:227]
    v_mfma_f32_16x16x32_bf16 v[228:231], a[132:135], v[32:35], v[228:231]
    v_mfma_f32_16x16x32_bf16 v[232:235], a[136:139], v[32:35], v[232:235]
    s_waitcnt vmcnt(11)
    v_mfma_f32_16x16x32_bf16 v[236:239], a[120:123], v[36:39], v[236:239]
    v_mfma_f32_16x16x32_bf16 v[240:243], a[124:127], v[36:39], v[240:243]
    buffer_load_dwordx4 v[28:31], v13, s[24:27], s48 offen sc1
    v_mfma_f32_16x16x32_bf16 v[244:247], a[128:131], v[36:39], v[244:247]
    v_mfma_f32_16x16x32_bf16 v[248:251], a[132:135], v[36:39], v[248:251]
    v_mfma_f32_16x16x32_bf16 v[252:255], a[136:139], v[36:39], v[252:255]
    s_waitcnt vmcnt(11)
    v_mfma_f32_16x16x32_bf16 v[176:179], a[140:143], v[40:43], v[176:179]
    v_mfma_f32_16x16x32_bf16 v[180:183], a[144:147], v[40:43], v[180:183]
    v_mfma_f32_16x16x32_bf16 v[184:187], a[148:151], v[40:43], v[184:187]
    v_mfma_f32_16x16x32_bf16 v[188:191], a[152:155], v[40:43], v[188:191]
    v_mfma_f32_16x16x32_bf16 v[192:195], a[156:159], v[40:43], v[192:195]
    s_waitcnt vmcnt(10)
    v_mfma_f32_16x16x32_bf16 v[196:199], a[140:143], v[44:47], v[196:199]
    v_mfma_f32_16x16x32_bf16 v[200:203], a[144:147], v[44:47], v[200:203]
    v_mfma_f32_16x16x32_bf16 v[204:207], a[148:151], v[44:47], v[204:207]
    v_mfma_f32_16x16x32_bf16 v[208:211], a[152:155], v[44:47], v[208:211]
    v_mfma_f32_16x16x32_bf16 v[212:215], a[156:159], v[44:47], v[212:215]
    s_waitcnt vmcnt(9)
    v_mfma_f32_16x16x32_bf16 v[216:219], a[140:143], v[48:51], v[216:219]
    v_mfma_f32_16x16x32_bf16 v[220:223], a[144:147], v[48:51], v[220:223]
    buffer_load_dwordx4 v[44:47], v13, s[24:27], s49 offen sc1
    buffer_load_dwordx4 v[80:83], v14, s[24:27], s96 offen sc1
    buffer_load_dwordx4 v[96:99], v14, s[24:27], s97 offen sc1
    v_mfma_f32_16x16x32_bf16 v[224:227], a[148:151], v[48:51], v[224:227]
    v_mfma_f32_16x16x32_bf16 v[228:231], a[152:155], v[48:51], v[228:231]
    v_mfma_f32_16x16x32_bf16 v[232:235], a[156:159], v[48:51], v[232:235]
    s_waitcnt vmcnt(11)
    v_mfma_f32_16x16x32_bf16 v[236:239], a[140:143], v[52:55], v[236:239]
    v_mfma_f32_16x16x32_bf16 v[240:243], a[144:147], v[52:55], v[240:243]
    buffer_load_dwordx4 v[112:115], v14, s[24:27], s98 offen sc1
    v_mfma_f32_16x16x32_bf16 v[244:247], a[148:151], v[52:55], v[244:247]
    v_mfma_f32_16x16x32_bf16 v[248:251], a[152:155], v[52:55], v[248:251]
    v_mfma_f32_16x16x32_bf16 v[252:255], a[156:159], v[52:55], v[252:255]
    s_waitcnt vmcnt(11)
    v_mfma_f32_16x16x32_bf16 v[176:179], a[160:163], v[56:59], v[176:179]
    v_mfma_f32_16x16x32_bf16 v[180:183], a[164:167], v[56:59], v[180:183]
    buffer_load_dwordx4 v[32:35], v14, s[24:27], s48 offen sc1
    v_mfma_f32_16x16x32_bf16 v[184:187], a[168:171], v[56:59], v[184:187]
    v_mfma_f32_16x16x32_bf16 v[188:191], a[172:175], v[56:59], v[188:191]
    v_mfma_f32_16x16x32_bf16 v[192:195], a[176:179], v[56:59], v[192:195]
    s_waitcnt vmcnt(11)
    v_mfma_f32_16x16x32_bf16 v[196:199], a[160:163], v[60:63], v[196:199]
    v_mfma_f32_16x16x32_bf16 v[200:203], a[164:167], v[60:63], v[200:203]
    buffer_load_dwordx4 v[48:51], v14, s[24:27], s49 offen sc1
    v_mfma_f32_16x16x32_bf16 v[204:207], a[168:171], v[60:63], v[204:207]
    v_mfma_f32_16x16x32_bf16 v[208:211], a[172:175], v[60:63], v[208:211]
    v_mfma_f32_16x16x32_bf16 v[212:215], a[176:179], v[60:63], v[212:215]
    s_waitcnt vmcnt(11)
    v_mfma_f32_16x16x32_bf16 v[216:219], a[160:163], v[64:67], v[216:219]
    v_mfma_f32_16x16x32_bf16 v[220:223], a[164:167], v[64:67], v[220:223]
    buffer_load_dwordx4 v[84:87], v15, s[24:27], s96 offen sc1
    v_mfma_f32_16x16x32_bf16 v[224:227], a[168:171], v[64:67], v[224:227]
    v_mfma_f32_16x16x32_bf16 v[228:231], a[172:175], v[64:67], v[228:231]
    v_mfma_f32_16x16x32_bf16 v[232:235], a[176:179], v[64:67], v[232:235]
    s_waitcnt vmcnt(11)
    v_mfma_f32_16x16x32_bf16 v[236:239], a[160:163], v[68:71], v[236:239]
    v_mfma_f32_16x16x32_bf16 v[240:243], a[164:167], v[68:71], v[240:243]
    buffer_load_dwordx4 v[100:103], v15, s[24:27], s97 offen sc1
    v_mfma_f32_16x16x32_bf16 v[244:247], a[168:171], v[68:71], v[244:247]
    v_mfma_f32_16x16x32_bf16 v[248:251], a[172:175], v[68:71], v[248:251]
    v_mfma_f32_16x16x32_bf16 v[252:255], a[176:179], v[68:71], v[252:255]
    s_waitcnt vmcnt(11)
    v_mfma_f32_16x16x32_bf16 v[196:199], a[180:183], v[76:79], v[196:199]
    v_mfma_f32_16x16x32_bf16 v[200:203], a[184:187], v[76:79], v[200:203]
    buffer_load_dwordx4 v[116:119], v15, s[24:27], s98 offen sc1
    v_mfma_f32_16x16x32_bf16 v[204:207], a[188:191], v[76:79], v[204:207]
    v_mfma_f32_16x16x32_bf16 v[208:211], a[192:195], v[76:79], v[208:211]
    v_mfma_f32_16x16x32_bf16 v[212:215], a[196:199], v[76:79], v[212:215]
    s_waitcnt vmcnt(11)
    v_mfma_f32_16x16x32_bf16 v[196:199], a[200:203], v[92:95], v[196:199]
    v_mfma_f32_16x16x32_bf16 v[200:203], a[204:207], v[92:95], v[200:203]
    buffer_load_dwordx4 v[36:39], v15, s[24:27], s48 offen sc1
    v_mfma_f32_16x16x32_bf16 v[204:207], a[208:211], v[92:95], v[204:207]
    v_mfma_f32_16x16x32_bf16 v[208:211], a[212:215], v[92:95], v[208:211]
    v_mfma_f32_16x16x32_bf16 v[212:215], a[216:219], v[92:95], v[212:215]
    s_waitcnt vmcnt(11)
    v_mfma_f32_16x16x32_bf16 v[196:199], a[220:223], v[108:111], v[196:199]
    v_mfma_f32_16x16x32_bf16 v[200:203], a[224:227], v[108:111], v[200:203]
    buffer_load_dwordx4 v[52:55], v15, s[24:27], s49 offen sc1
    v_mfma_f32_16x16x32_bf16 v[204:207], a[228:231], v[108:111], v[204:207]
    v_mfma_f32_16x16x32_bf16 v[208:211], a[232:235], v[108:111], v[208:211]
    v_mfma_f32_16x16x32_bf16 v[212:215], a[236:239], v[108:111], v[212:215]
    s_waitcnt vmcnt(11)
    v_mfma_f32_16x16x32_bf16 v[196:199], v[136:139], v[28:31], v[196:199]
    v_mfma_f32_16x16x32_bf16 v[200:203], v[140:143], v[28:31], v[200:203]
    buffer_load_dwordx4 v[72:75], v12, s[24:27], s96 offen sc1
    v_mfma_f32_16x16x32_bf16 v[204:207], v[144:147], v[28:31], v[204:207]
    v_mfma_f32_16x16x32_bf16 v[208:211], v[148:151], v[28:31], v[208:211]
    v_mfma_f32_16x16x32_bf16 v[212:215], v[152:155], v[28:31], v[212:215]
    s_waitcnt vmcnt(11)
    v_mfma_f32_16x16x32_bf16 v[196:199], v[156:159], v[44:47], v[196:199]
    v_mfma_f32_16x16x32_bf16 v[200:203], v[160:163], v[44:47], v[200:203]
    buffer_load_dwordx4 v[88:91], v12, s[24:27], s97 offen sc1
    v_mfma_f32_16x16x32_bf16 v[204:207], v[164:167], v[44:47], v[204:207]
    v_mfma_f32_16x16x32_bf16 v[208:211], v[168:171], v[44:47], v[208:211]
    v_mfma_f32_16x16x32_bf16 v[212:215], v[172:175], v[44:47], v[212:215]
    s_waitcnt vmcnt(11)
    v_mfma_f32_16x16x32_bf16 v[216:219], a[180:183], v[80:83], v[216:219]
    v_mfma_f32_16x16x32_bf16 v[220:223], a[184:187], v[80:83], v[220:223]
    buffer_load_dwordx4 v[104:107], v12, s[24:27], s98 offen sc1
    v_mfma_f32_16x16x32_bf16 v[224:227], a[188:191], v[80:83], v[224:227]
    v_mfma_f32_16x16x32_bf16 v[228:231], a[192:195], v[80:83], v[228:231]
    v_mfma_f32_16x16x32_bf16 v[232:235], a[196:199], v[80:83], v[232:235]
    ds_write_b128 v16, v[196:199] offset:0
    s_waitcnt vmcnt(11)
    v_mfma_f32_16x16x32_bf16 v[216:219], a[200:203], v[96:99], v[216:219]
    v_mfma_f32_16x16x32_bf16 v[220:223], a[204:207], v[96:99], v[220:223]
    buffer_load_dwordx4 v[24:27], v12, s[24:27], s48 offen sc1
    v_mfma_f32_16x16x32_bf16 v[224:227], a[208:211], v[96:99], v[224:227]
    ds_write_b128 v16, v[200:203] offset:1024
    v_mfma_f32_16x16x32_bf16 v[228:231], a[212:215], v[96:99], v[228:231]
    v_mfma_f32_16x16x32_bf16 v[232:235], a[216:219], v[96:99], v[232:235]
    ds_write_b128 v16, v[204:207] offset:2048
    s_waitcnt vmcnt(11)
    v_mfma_f32_16x16x32_bf16 v[216:219], a[220:223], v[112:115], v[216:219]
    v_mfma_f32_16x16x32_bf16 v[220:223], a[224:227], v[112:115], v[220:223]
    buffer_load_dwordx4 v[40:43], v12, s[24:27], s49 offen sc1
    v_mfma_f32_16x16x32_bf16 v[224:227], a[228:231], v[112:115], v[224:227]
    ds_write_b128 v16, v[208:211] offset:3072
    v_mfma_f32_16x16x32_bf16 v[228:231], a[232:235], v[112:115], v[228:231]
    v_mfma_f32_16x16x32_bf16 v[232:235], a[236:239], v[112:115], v[232:235]
    ds_write_b128 v16, v[212:215] offset:4096
    s_waitcnt vmcnt(11)
    v_mfma_f32_16x16x32_bf16 v[216:219], v[136:139], v[32:35], v[216:219]
    v_mfma_f32_16x16x32_bf16 v[220:223], v[140:143], v[32:35], v[220:223]
    v_mfma_f32_16x16x32_bf16 v[224:227], v[144:147], v[32:35], v[224:227]
    v_mfma_f32_16x16x32_bf16 v[228:231], v[148:151], v[32:35], v[228:231]
    v_mfma_f32_16x16x32_bf16 v[232:235], v[152:155], v[32:35], v[232:235]
    s_waitcnt vmcnt(10)
    v_mfma_f32_16x16x32_bf16 v[216:219], v[156:159], v[48:51], v[216:219]
    v_mfma_f32_16x16x32_bf16 v[220:223], v[160:163], v[48:51], v[220:223]
    v_mfma_f32_16x16x32_bf16 v[224:227], v[164:167], v[48:51], v[224:227]
    v_mfma_f32_16x16x32_bf16 v[228:231], v[168:171], v[48:51], v[228:231]
    v_mfma_f32_16x16x32_bf16 v[232:235], v[172:175], v[48:51], v[232:235]
    s_waitcnt vmcnt(9)
    v_mfma_f32_16x16x32_bf16 v[236:239], a[180:183], v[84:87], v[236:239]
    v_mfma_f32_16x16x32_bf16 v[240:243], a[184:187], v[84:87], v[240:243]
    v_mfma_f32_16x16x32_bf16 v[244:247], a[188:191], v[84:87], v[244:247]
    v_mfma_f32_16x16x32_bf16 v[248:251], a[192:195], v[84:87], v[248:251]
    v_mfma_f32_16x16x32_bf16 v[252:255], a[196:199], v[84:87], v[252:255]
    ds_write_b128 v17, v[216:219] offset:0
    s_waitcnt vmcnt(8)
    v_mfma_f32_16x16x32_bf16 v[236:239], a[200:203], v[100:103], v[236:239]
    v_mfma_f32_16x16x32_bf16 v[240:243], a[204:207], v[100:103], v[240:243]
    v_mfma_f32_16x16x32_bf16 v[244:247], a[208:211], v[100:103], v[244:247]
    ds_write_b128 v17, v[220:223] offset:1024
    v_mfma_f32_16x16x32_bf16 v[248:251], a[212:215], v[100:103], v[248:251]
    v_mfma_f32_16x16x32_bf16 v[252:255], a[216:219], v[100:103], v[252:255]
    ds_write_b128 v17, v[224:227] offset:2048
    s_waitcnt vmcnt(7)
    v_mfma_f32_16x16x32_bf16 v[236:239], a[220:223], v[116:119], v[236:239]
    v_mfma_f32_16x16x32_bf16 v[240:243], a[224:227], v[116:119], v[240:243]
    v_mfma_f32_16x16x32_bf16 v[244:247], a[228:231], v[116:119], v[244:247]
    ds_write_b128 v17, v[228:231] offset:3072
    v_mfma_f32_16x16x32_bf16 v[248:251], a[232:235], v[116:119], v[248:251]
    v_mfma_f32_16x16x32_bf16 v[252:255], a[236:239], v[116:119], v[252:255]
    ds_write_b128 v17, v[232:235] offset:4096
    s_waitcnt vmcnt(6)
    v_mfma_f32_16x16x32_bf16 v[236:239], v[136:139], v[36:39], v[236:239]
    v_mfma_f32_16x16x32_bf16 v[240:243], v[140:143], v[36:39], v[240:243]
    v_mfma_f32_16x16x32_bf16 v[244:247], v[144:147], v[36:39], v[244:247]
    v_mfma_f32_16x16x32_bf16 v[248:251], v[148:151], v[36:39], v[248:251]
    v_mfma_f32_16x16x32_bf16 v[252:255], v[152:155], v[36:39], v[252:255]
    s_waitcnt vmcnt(5)
    v_mfma_f32_16x16x32_bf16 v[236:239], v[156:159], v[52:55], v[236:239]
    v_mfma_f32_16x16x32_bf16 v[240:243], v[160:163], v[52:55], v[240:243]
    v_mfma_f32_16x16x32_bf16 v[244:247], v[164:167], v[52:55], v[244:247]
    v_mfma_f32_16x16x32_bf16 v[248:251], v[168:171], v[52:55], v[248:251]
    v_mfma_f32_16x16x32_bf16 v[252:255], v[172:175], v[52:55], v[252:255]
    s_waitcnt vmcnt(4)
    v_mfma_f32_16x16x32_bf16 v[176:179], a[180:183], v[72:75], v[176:179]
    v_mfma_f32_16x16x32_bf16 v[180:183], a[184:187], v[72:75], v[180:183]
    v_mfma_f32_16x16x32_bf16 v[184:187], a[188:191], v[72:75], v[184:187]
    v_mfma_f32_16x16x32_bf16 v[188:191], a[192:195], v[72:75], v[188:191]
    v_mfma_f32_16x16x32_bf16 v[192:195], a[196:199], v[72:75], v[192:195]
    ds_write_b128 v18, v[236:239] offset:0
    s_waitcnt vmcnt(3)
    v_mfma_f32_16x16x32_bf16 v[176:179], a[200:203], v[88:91], v[176:179]
    v_mfma_f32_16x16x32_bf16 v[180:183], a[204:207], v[88:91], v[180:183]
    v_mfma_f32_16x16x32_bf16 v[184:187], a[208:211], v[88:91], v[184:187]
    ds_write_b128 v18, v[240:243] offset:1024
    v_mfma_f32_16x16x32_bf16 v[188:191], a[212:215], v[88:91], v[188:191]
    v_mfma_f32_16x16x32_bf16 v[192:195], a[216:219], v[88:91], v[192:195]
    ds_write_b128 v18, v[244:247] offset:2048
    s_waitcnt vmcnt(2)
    v_mfma_f32_16x16x32_bf16 v[176:179], a[220:223], v[104:107], v[176:179]
    v_mfma_f32_16x16x32_bf16 v[180:183], a[224:227], v[104:107], v[180:183]
    v_mfma_f32_16x16x32_bf16 v[184:187], a[228:231], v[104:107], v[184:187]
    ds_write_b128 v18, v[248:251] offset:3072
    v_mfma_f32_16x16x32_bf16 v[188:191], a[232:235], v[104:107], v[188:191]
    v_mfma_f32_16x16x32_bf16 v[192:195], a[236:239], v[104:107], v[192:195]
    ds_write_b128 v18, v[252:255] offset:4096
    s_waitcnt vmcnt(1)
    v_mfma_f32_16x16x32_bf16 v[176:179], v[136:139], v[24:27], v[176:179]
    v_mfma_f32_16x16x32_bf16 v[180:183], v[140:143], v[24:27], v[180:183]
    v_mfma_f32_16x16x32_bf16 v[184:187], v[144:147], v[24:27], v[184:187]
    v_mfma_f32_16x16x32_bf16 v[188:191], v[148:151], v[24:27], v[188:191]
    v_mfma_f32_16x16x32_bf16 v[192:195], v[152:155], v[24:27], v[192:195]
    s_waitcnt lgkmcnt(0)
    s_barrier
    ds_read_b128 v[196:199], v19 offset:0
    ds_read_b128 v[200:203], v19 offset:1024
    ds_read_b128 v[204:207], v19 offset:2048
    ds_read_b128 v[208:211], v19 offset:3072
    ds_read_b128 v[212:215], v19 offset:4096
    ds_read_b128 v[216:219], v19 offset:5120
    ds_read_b128 v[220:223], v19 offset:6144
    ds_read_b128 v[224:227], v19 offset:7168
    ds_read_b128 v[228:231], v19 offset:8192
    ds_read_b128 v[232:235], v19 offset:9216
    ds_read_b128 v[236:239], v19 offset:10240
    ds_read_b128 v[240:243], v19 offset:11264
    ds_read_b128 v[244:247], v19 offset:12288
    ds_read_b128 v[248:251], v19 offset:13312
    ds_read_b128 v[252:255], v19 offset:14336
    s_waitcnt vmcnt(0)
    v_mfma_f32_16x16x32_bf16 v[176:179], v[156:159], v[40:43], v[176:179]
    v_mfma_f32_16x16x32_bf16 v[180:183], v[160:163], v[40:43], v[180:183]
    v_mfma_f32_16x16x32_bf16 v[184:187], v[164:167], v[40:43], v[184:187]
    v_mfma_f32_16x16x32_bf16 v[188:191], v[168:171], v[40:43], v[188:191]
    v_mfma_f32_16x16x32_bf16 v[192:195], v[172:175], v[40:43], v[192:195]
    s_nop 7
    s_waitcnt lgkmcnt(14)
    v_pk_add_f32 v[176:177], v[176:177], v[196:197]
    v_pk_add_f32 v[178:179], v[178:179], v[198:199]
    s_waitcnt lgkmcnt(9)
    v_pk_add_f32 v[176:177], v[176:177], v[216:217]
    v_pk_add_f32 v[178:179], v[178:179], v[218:219]
    s_waitcnt lgkmcnt(4)
    v_pk_add_f32 v[176:177], v[176:177], v[236:237]
    v_pk_add_f32 v[178:179], v[178:179], v[238:239]
    v_cvt_pk_bf16_f32 v196, v176, v177
    v_cvt_pk_bf16_f32 v197, v178, v179
    buffer_store_dwordx2 v[196:197], v20, s[28:31], s101 offen offset:0
    v_pk_add_f32 v[180:181], v[180:181], v[200:201]
    v_pk_add_f32 v[182:183], v[182:183], v[202:203]
    v_pk_add_f32 v[180:181], v[180:181], v[220:221]
    v_pk_add_f32 v[182:183], v[182:183], v[222:223]
    s_waitcnt lgkmcnt(3)
    v_pk_add_f32 v[180:181], v[180:181], v[240:241]
    v_pk_add_f32 v[182:183], v[182:183], v[242:243]
    v_cvt_pk_bf16_f32 v200, v180, v181
    v_cvt_pk_bf16_f32 v201, v182, v183
    buffer_store_dwordx2 v[200:201], v20, s[28:31], s101 offen offset:32
    v_pk_add_f32 v[184:185], v[184:185], v[204:205]
    v_pk_add_f32 v[186:187], v[186:187], v[206:207]
    v_pk_add_f32 v[184:185], v[184:185], v[224:225]
    v_pk_add_f32 v[186:187], v[186:187], v[226:227]
    s_waitcnt lgkmcnt(2)
    v_pk_add_f32 v[184:185], v[184:185], v[244:245]
    v_pk_add_f32 v[186:187], v[186:187], v[246:247]
    v_cvt_pk_bf16_f32 v204, v184, v185
    v_cvt_pk_bf16_f32 v205, v186, v187
    buffer_store_dwordx2 v[204:205], v20, s[28:31], s101 offen offset:64
    v_pk_add_f32 v[188:189], v[188:189], v[208:209]
    v_pk_add_f32 v[190:191], v[190:191], v[210:211]
    v_pk_add_f32 v[188:189], v[188:189], v[228:229]
    v_pk_add_f32 v[190:191], v[190:191], v[230:231]
    s_waitcnt lgkmcnt(1)
    v_pk_add_f32 v[188:189], v[188:189], v[248:249]
    v_pk_add_f32 v[190:191], v[190:191], v[250:251]
    v_cvt_pk_bf16_f32 v208, v188, v189
    v_cvt_pk_bf16_f32 v209, v190, v191
    buffer_store_dwordx2 v[208:209], v20, s[28:31], s101 offen offset:96
    v_pk_add_f32 v[192:193], v[192:193], v[212:213]
    v_pk_add_f32 v[194:195], v[194:195], v[214:215]
    v_pk_add_f32 v[192:193], v[192:193], v[232:233]
    v_pk_add_f32 v[194:195], v[194:195], v[234:235]
    s_waitcnt lgkmcnt(0)
    v_pk_add_f32 v[192:193], v[192:193], v[252:253]
    v_pk_add_f32 v[194:195], v[194:195], v[254:255]
    v_cvt_pk_bf16_f32 v212, v192, v193
    v_cvt_pk_bf16_f32 v213, v194, v195
    buffer_store_dwordx2 v[212:213], v20, s[28:31], s101 offen offset:128
L_end:
L_codeend:
    s_endpgm
.section .rodata,"a"
.p2align 6
.amdhsa_kernel standalone__dense_activation_relu__prompt_kernel
  .amdhsa_next_free_vgpr 512
  .amdhsa_next_free_sgpr 102
  .amdhsa_accum_offset 256
  .amdhsa_group_segment_fixed_size 0
  .amdhsa_kernarg_size 48
  .amdhsa_user_sgpr_count 2
  .amdhsa_user_sgpr_kernarg_segment_ptr 1
  .amdhsa_system_sgpr_workgroup_id_x 1
.end_amdhsa_kernel
```
